```python
import torch

def _softmax(x, axis=-1):
    return torch.softmax(x, dim=axis)

def _gelu(x):
    return torch.nn.functional.gelu(x, approximate='tanh')

def _silu(x):
    return torch.nn.functional.silu(x)

def _sigmoid(x):
    return torch.sigmoid(x)

def _layernorm(x, axis=-1, eps=1e-05):
    m = x.mean(dim=axis, keepdim=True)
    v = x.var(dim=axis, keepdim=True, unbiased=False)
    return (x - m) / torch.sqrt(v + eps)

def _scatter_add(tgt, idx, src, axis=0):
    return tgt.clone().index_add_(axis, idx, src)

def _segment_sum(src, seg, n):
    out = torch.zeros((n,) + src.shape[1:], dtype=src.dtype)
    return out.index_add_(0, seg, src)

def _pad(x, pw):
    flat = tuple((v for pair in reversed(pw) for v in pair))
    return torch.nn.functional.pad(x, flat)
kernel_name = 'adaLN_cond__sliding_block_cached__swiglu_ffn__decode'

def setup_inputs():

    _w = lambda a: (lambda t: t.to(torch.bfloat16) if t.is_floating_point() else t)(torch.as_tensor(a))

    def _A_setup():
        B, Sq, D = (2, 1, 448)
        Hq, Hkv, Sk, Dh = (16, 8, 32768, 256)
        assert Hq % Hkv == 0, (Hq, Hkv)
        return {'x': _w((lambda *s: torch.randn(*s, dtype=torch.bfloat16) * 0.05)(B, Sq, D)), 'k_cache': _w((lambda *s: torch.randn(*s, dtype=torch.bfloat16) * 3.2)(B, Hkv, Sk, Dh)), 'v_cache': _w((lambda *s: torch.randn(*s, dtype=torch.bfloat16) * 0.4)(B, Hkv, Sk, Dh)), 'wq': _w((lambda *s: torch.randn(*s, dtype=torch.bfloat16) * 3.2)(D, Hq * Dh) * D ** (-0.5)), 'wo': _w((lambda *s: torch.randn(*s, dtype=torch.bfloat16) * 0.4)(Hq * Dh, D) * (Hq * Dh) ** (-0.5))}
    _A_in = _A_setup()

    def _B_setup():
        B, S, D, F = (2, 1, 448, 1792)
        return {'x': _w((lambda *s: torch.randn(*s, dtype=torch.bfloat16) * 0.05)(B, S, D)), 'w_gate': _w((lambda *s: torch.randn(*s, dtype=torch.bfloat16) * 0.05)(D, F)), 'w_up': _w((lambda *s: torch.randn(*s, dtype=torch.bfloat16) * 0.05)(D, F)), 'w_down': _w((lambda *s: torch.randn(*s, dtype=torch.bfloat16) * 0.05)(F, D))}
    _B_in = _B_setup()
    return {'A_x': _A_in['x'], 'A_k_cache': _A_in['k_cache'], 'A_v_cache': _A_in['v_cache'], 'A_wq': _A_in['wq'], 'A_wo': _A_in['wo'], 'B_x': _B_in['x'], 'B_w_gate': _B_in['w_gate'], 'B_w_up': _B_in['w_up'], 'B_w_down': _B_in['w_down'], 'c': _w((lambda *s: torch.randn(*s, dtype=torch.bfloat16) * 0.1)(2, 448) * 8.0), 'w_mod': _w((lambda *s: torch.randn(*s, dtype=torch.bfloat16) * 0.1)(448, 6 * 448) * 448 ** (-0.5) * 8.0)}

def reference(A_x, A_k_cache, A_v_cache, A_wq, A_wo, B_x, B_w_gate, B_w_up, B_w_down, c, w_mod):

    def _A_ref(x, k_cache, v_cache, wq, wo):
        B, Sq, D = x.shape
        Hq, Dh = (16, 256)
        Hkv, Sk = (k_cache.shape[1], k_cache.shape[2])
        W = min(4096, max(256, Sk // 4))
        rep = Hq // Hkv
        q = (lambda x, *d: x.permute(*d))((x @ wq).reshape(B, Sq, Hq, Dh), 0, 2, 1, 3)
        k = (lambda x, n, axis: torch.repeat_interleave(x, n, dim=axis))(k_cache[:, :, Sk - W:, :], rep, axis=1)
        v = (lambda x, n, axis: torch.repeat_interleave(x, n, dim=axis))(v_cache[:, :, Sk - W:, :], rep, axis=1)
        scores = torch.einsum('bhqd,bhkd->bhqk', q, k) * Dh ** (-0.5)
        p = _softmax(scores, axis=-1)
        o = torch.einsum('bhqk,bhkd->bhqd', p, v)
        return (lambda x, *d: x.permute(*d))(o, 0, 2, 1, 3).reshape(B, Sq, Hq * Dh) @ wo

    def _B_ref(x, w_gate, w_up, w_down):
        g = _silu(x @ w_gate)
        u = x @ w_up
        return g * u @ w_down
    x = A_x
    mod = (_silu(c) @ w_mod).reshape(c.shape[0], 6, 1, -1)
    sa, ca, ga, sb, cb, gb = (mod[:, 0].clone(), mod[:, 1].clone(), mod[:, 2].clone(), mod[:, 3].clone(), mod[:, 4].clone(), mod[:, 5].clone())
    h = _layernorm(x, axis=-1) * (1 + ca) + sa
    x = x + ga * _A_ref(h, A_k_cache, A_v_cache, A_wq, A_wo)
    h = _layernorm(x, axis=-1) * (1 + cb) + sb
    x = x + gb * _B_ref(h, B_w_gate, B_w_up, B_w_down)
    return x
```

```asm
; @launch grid=(256,1,1) block=(512,1,1) lds=163840
.amdgcn_target "amdgcn-amd-amdhsa--gfx950"
.text
.globl adaLN_cond__sliding_block_cached__swiglu_ffn__decode_kernel
.p2align 8
.type adaLN_cond__sliding_block_cached__swiglu_ffn__decode_kernel,@function
adaLN_cond__sliding_block_cached__swiglu_ffn__decode_kernel:
    s_cmp_ge_u32 s2, 256
    s_cbranch_scc1 L_exit
    s_load_dwordx16 s[8:23], s[0:1], 0
    s_load_dwordx8 s[24:31], s[0:1], 64
    s_load_dwordx2 s[32:33], s[0:1], 104
    s_getpc_b64 s[52:53]
L_pc:
    s_and_b32 s54, s2, 0xf8
    v_lshrrev_b32 v4, 6, v0
    v_add_lshl_u32 v4, v4, s54, 7
    v_mov_b32 v7, s53
    v_add_co_u32 v6, vcc, s52, v4
    s_nop 1
    v_addc_co_u32 v7, vcc, 0, v7, vcc
    v_cmp_ge_u32 vcc, L_exit-L_pc, v4
    s_cbranch_vccz L_nopf
    s_mov_b64 exec, 1
    global_load_dword v63, v[6:7], off
    s_mov_b64 exec, -1
L_nopf:
    v_mov_b32 v8, 163360
    v_mov_b32 v10, 0
    v_mov_b32 v11, 0
    ds_write_b64 v8, v[10:11]
    ds_write_b64 v8, v[10:11] offset:8
    ds_write_b64 v8, v[10:11] offset:16
    v_and_b32 v9, 63, v0
    v_lshlrev_b32 v9, 2, v9
    v_add_u32 v9, 163104, v9
    v_mov_b32 v12, -1
    ds_write_b32 v9, v12
    v_lshrrev_b32 v1, 6, v0
    v_and_b32 v0, 63, v0
    v_readfirstlane_b32 s3, v1
    s_and_b32 s4, s2, 7
    s_lshr_b32 s5, s2, 3
    v_lshrrev_b32 v1, 4, v0
    v_and_b32 v2, 15, v0
    s_and_b32 s6, s5, 1
    s_lshr_b32 s7, s5, 1
    s_lshl_b32 s52, s7, 2
    s_lshr_b32 s52, 0x37654210, s52
    s_and_b32 s52, s52, 7
    s_lshl_b32 s53, s4, 3
    s_add_u32 s53, s53, s52
    s_mul_i32 s56, s4, 6
    s_add_u32 s56, s56, s7
    s_sub_u32 s56, s56, 6
    s_mov_b32 s69, s6
    s_cmp_lt_u32 s5, 12
    s_cselect_b32 s55, s4, 0
    s_cmp_lg_u32 s55, 0
    s_cselect_b32 s70, 2, 0
    s_cselect_b32 s50, 2408448, 0
    s_movk_i32 s58, 5376
    s_cmp_ge_u32 s2, 128
    s_cselect_b32 s70, 1, s70
    s_cselect_b32 s68, s53, s56
    s_cselect_b32 s58, 8192, s58
    s_cselect_b32 s50, 3670016, s50
    v_lshrrev_b32 v3, 3, v0
    v_mul_u32_u24 v3, s58, v3
    v_and_b32 v4, 7, v0
    v_lshlrev_b32 v5, 1, v1
    v_xor_b32 v4, v4, v5
    v_lshl_add_u32 v3, v4, 4, v3
    s_and_b32 s71, s3, 3
    s_mul_i32 s59, s69, 28
    s_add_u32 s59, s59, s3
    s_lshl_b32 s60, s58, 3
    s_mul_i32 s59, s59, s60
    s_lshl_b32 s61, s68, 7
    s_add_u32 s59, s59, s61
    s_lshl_b32 s60, s60, 3
    s_lshl_b32 s61, s3, 10
    s_mov_b32 s51, 0x20000
    s_waitcnt lgkmcnt(0)
    s_load_dword s34, s[32:33], 0
    s_cmp_ge_u32 s2, 128
    s_cselect_b32 s48, s14, s28
    s_cselect_b32 s49, s15, s29
    s_mov_b32 s36, s32
    s_mov_b32 s37, s33
    s_mov_b32 s38, 983040
    s_mov_b32 s39, 0x20000
    s_add_u32 m0, s61, 131072
    s_nop 0
    buffer_load_dwordx4 v3, s[48:51], s59 offen nt lds
    s_add_u32 m0, s61, 139264
    s_add_u32 s59, s59, s60
    buffer_load_dwordx4 v3, s[48:51], s59 offen nt lds
    s_add_u32 m0, s61, 147456
    s_add_u32 s59, s59, s60
    buffer_load_dwordx4 v3, s[48:51], s59 offen nt lds
    s_cmp_ge_u32 s3, 4
    s_cbranch_scc1 L_X
    s_add_u32 m0, s61, 155648
    s_add_u32 s59, s59, s60
    buffer_load_dwordx4 v3, s[48:51], s59 offen nt lds
    s_lshl_b32 s52, s6, 3
    s_add_u32 s52, s52, s4
    s_lshl_b32 s52, s52, 24
    s_lshl_b32 s53, s7, 17
    s_add_u32 s52, s52, s53
    s_add_u32 s52, s52, 14680064
    s_add_u32 s40, s10, s52
    s_addc_u32 s41, s11, 0
    s_mov_b32 s42, 131072
    s_mov_b32 s43, 0x20000
    s_add_u32 s44, s12, s52
    s_addc_u32 s45, s13, 0
    s_mov_b32 s46, 131072
    s_mov_b32 s47, 0x20000
    v_lshrrev_b32 v8, 5, v0
    v_and_b32 v9, 31, v0
    v_lshlrev_b32 v10, 1, v8
    v_xor_b32 v9, v9, v10
    v_lshlrev_b32 v8, 9, v8
    v_lshl_add_u32 v4, v9, 4, v8
    v_xor_b32 v5, 64, v4
    v_xor_b32 v6, 128, v4
    v_xor_b32 v7, 192, v4
    s_add_u32 s52, s3, s7
    s_lshl_b32 s53, s6, 12
    s_lshl_b32 s62, s3, 12
    s_movk_i32 s98, 0
    s_cmp_lt_u32 s5, 28
    s_cselect_b32 s98, 0, s98
    s_cmp_lt_u32 s5, 14
    s_cselect_b32 s98, 0, s98
    s_cmp_eq_u32 s4, 7
    s_cselect_b32 s63, 28, 30
    s_cmp_ge_u32 s5, s63
    s_cselect_b32 s98, 271, s98
    s_barrier
    s_add_u32 s63, s52, 0
    s_and_b32 s63, s63, 15
    s_lshl_b32 s63, s63, 13
    s_add_u32 s54, s63, s53
    s_xor_b32 s55, s54, 4096
    s_bitcmp1_b32 s98, 0
    s_cselect_b64 vcc, -1, 0
    s_add_u32 m0, s62, 0
    s_waitcnt vmcnt(3)
    buffer_load_dwordx4 v4, s[40:43], s54 offen offset:0 nt lds
    s_waitcnt vmcnt(3)
    buffer_load_dwordx4 v5, s[40:43], s54 offen offset:1024 nt lds
    s_waitcnt vmcnt(3)
    buffer_load_dwordx4 v6, s[40:43], s54 offen offset:2048 nt lds
    s_waitcnt vmcnt(3)
    v_mov_b32 v12, 163360
    v_mov_b32 v13, 1
    s_mov_b64 exec, 1
    ds_add_u32 v12, v13 offset:12
    s_mov_b64 exec, -1
    buffer_load_dwordx4 v7, s[40:43], s54 offen offset:3072 nt lds
    s_add_u32 m0, s62, 16384
    s_waitcnt vmcnt(6)
    s_cbranch_vccnz L_t_1
    s_waitcnt vmcnt(5)
L_t_1:
    buffer_load_dwordx4 v4, s[40:43], s55 offen offset:0 nt lds
    s_waitcnt vmcnt(6)
    s_cbranch_vccnz L_t_2
    s_waitcnt vmcnt(5)
L_t_2:
    buffer_load_dwordx4 v5, s[40:43], s55 offen offset:1024 nt lds
    s_waitcnt vmcnt(6)
    s_cbranch_vccnz L_t_3
    s_waitcnt vmcnt(5)
L_t_3:
    buffer_load_dwordx4 v6, s[40:43], s55 offen offset:2048 nt lds
    s_waitcnt vmcnt(6)
    s_cbranch_vccnz L_t_4
    s_waitcnt vmcnt(5)
L_t_4:
    buffer_load_dwordx4 v7, s[40:43], s55 offen offset:3072 nt lds
    v_and_b32 v14, 7, v2
    v_lshrrev_b32 v15, 3, v2
    v_lshlrev_b32 v15, 14, v15
    v_lshl_add_u32 v15, v14, 9, v15
    v_add_u32 v15, s62, v15
    v_lshlrev_b32 v14, 1, v14
    v_xor_b32 v14, v14, v1
    v_lshl_add_u32 v8, v14, 4, v15
    v_xor_b32 v9, 64, v8
    v_xor_b32 v10, 128, v8
    v_xor_b32 v11, 192, v8
    s_add_u32 s63, s52, 4
    s_and_b32 s63, s63, 15
    s_lshl_b32 s63, s63, 13
    s_add_u32 s56, s63, s53
    s_xor_b32 s57, s56, 4096
    s_bitcmp1_b32 s98, 1
    s_cselect_b64 vcc, -1, 0
    s_add_u32 m0, s62, 32768
    s_waitcnt vmcnt(6)
    s_cbranch_vccnz L_t_5
    s_waitcnt vmcnt(5)
L_t_5:
    buffer_load_dwordx4 v4, s[40:43], s56 offen offset:0 nt lds
    s_waitcnt vmcnt(6)
    s_cbranch_vccnz L_t_6
    s_waitcnt vmcnt(5)
L_t_6:
    buffer_load_dwordx4 v5, s[40:43], s56 offen offset:1024 nt lds
    s_waitcnt vmcnt(6)
    s_cbranch_vccnz L_t_7
    s_waitcnt vmcnt(5)
L_t_7:
    buffer_load_dwordx4 v6, s[40:43], s56 offen offset:2048 nt lds
    s_waitcnt vmcnt(6)
    s_cbranch_vccnz L_t_8
    s_waitcnt vmcnt(5)
L_t_8:
    buffer_load_dwordx4 v7, s[40:43], s56 offen offset:3072 nt lds
    s_add_u32 m0, s62, 49152
    s_waitcnt vmcnt(6)
    s_cbranch_vccnz L_t_9
    s_waitcnt vmcnt(5)
L_t_9:
    buffer_load_dwordx4 v4, s[40:43], s57 offen offset:0 nt lds
    s_waitcnt vmcnt(6)
    s_cbranch_vccnz L_t_10
    s_waitcnt vmcnt(5)
L_t_10:
    buffer_load_dwordx4 v5, s[40:43], s57 offen offset:1024 nt lds
    s_waitcnt vmcnt(6)
    s_cbranch_vccnz L_t_11
    s_waitcnt vmcnt(5)
L_t_11:
    buffer_load_dwordx4 v6, s[40:43], s57 offen offset:2048 nt lds
    s_waitcnt vmcnt(6)
    s_cbranch_vccnz L_t_12
    s_waitcnt vmcnt(5)
L_t_12:
    buffer_load_dwordx4 v7, s[40:43], s57 offen offset:3072 nt lds
    s_add_u32 s63, s52, 8
    s_and_b32 s63, s63, 15
    s_lshl_b32 s63, s63, 13
    s_add_u32 s58, s63, s53
    s_xor_b32 s59, s58, 4096
    s_waitcnt vmcnt(8)
    ds_read_b128 v[128:131], v8 offset:0
    ds_read_b128 v[132:135], v9 offset:0
    ds_read_b128 v[136:139], v10 offset:0
    ds_read_b128 v[140:143], v11 offset:0
    ds_read_b128 v[144:147], v8 offset:256
    ds_read_b128 v[148:151], v9 offset:256
    ds_read_b128 v[152:155], v10 offset:256
    ds_read_b128 v[156:159], v11 offset:256
    s_bitcmp1_b32 s98, 2
    s_cselect_b64 vcc, -1, 0
    s_add_u32 m0, s62, 65536
    s_waitcnt vmcnt(6)
    s_cbranch_vccnz L_t_13
    s_waitcnt vmcnt(5)
L_t_13:
    buffer_load_dwordx4 v4, s[40:43], s58 offen offset:0 nt lds
    s_waitcnt vmcnt(6)
    s_cbranch_vccnz L_t_14
    s_waitcnt vmcnt(5)
L_t_14:
    buffer_load_dwordx4 v5, s[40:43], s58 offen offset:1024 nt lds
    s_bitcmp1_b32 s98, 8
    s_cbranch_scc0 L_me
    v_mov_b32 v12, 163360
    v_mov_b32 v13, 1
    ds_write_b32 v12, v13 offset:8
L_me:
    s_waitcnt vmcnt(6)
    s_cbranch_vccnz L_t_15
    s_waitcnt vmcnt(5)
L_t_15:
    buffer_load_dwordx4 v6, s[40:43], s58 offen offset:2048 nt lds
    s_waitcnt vmcnt(6)
    s_cbranch_vccnz L_t_16
    s_waitcnt vmcnt(5)
L_t_16:
    buffer_load_dwordx4 v7, s[40:43], s58 offen offset:3072 nt lds
    s_add_u32 m0, s62, 81920
    s_waitcnt vmcnt(6)
    s_cbranch_vccnz L_t_17
    s_waitcnt vmcnt(5)
L_t_17:
    buffer_load_dwordx4 v4, s[40:43], s59 offen offset:0 nt lds
    v_mov_b32 v12, 163360
    v_mov_b32 v13, 1
    ds_write_b32 v12, v13 offset:8
    s_waitcnt vmcnt(6)
    s_cbranch_vccnz L_t_18
    s_waitcnt vmcnt(5)
L_t_18:
    buffer_load_dwordx4 v5, s[40:43], s59 offen offset:1024 nt lds
    s_waitcnt vmcnt(6)
    s_cbranch_vccnz L_t_19
    s_waitcnt vmcnt(5)
L_t_19:
    buffer_load_dwordx4 v6, s[40:43], s59 offen offset:2048 nt lds
    s_waitcnt vmcnt(6)
    s_cbranch_vccnz L_t_20
    s_waitcnt vmcnt(5)
L_t_20:
    buffer_load_dwordx4 v7, s[40:43], s59 offen offset:3072 nt lds
    s_add_u32 s63, s52, 12
    s_and_b32 s63, s63, 15
    s_lshl_b32 s63, s63, 13
    s_add_u32 s60, s63, s53
    s_xor_b32 s61, s60, 4096
    s_waitcnt vmcnt(8) lgkmcnt(0)
    ds_read_b128 v[160:163], v8 offset:32768
    ds_read_b128 v[164:167], v9 offset:32768
    ds_read_b128 v[168:171], v10 offset:32768
    ds_read_b128 v[172:175], v11 offset:32768
    ds_read_b128 v[176:179], v8 offset:33024
    ds_read_b128 v[180:183], v9 offset:33024
    ds_read_b128 v[184:187], v10 offset:33024
    ds_read_b128 v[188:191], v11 offset:33024
    s_bitcmp1_b32 s98, 3
    s_cselect_b64 vcc, -1, 0
    s_add_u32 m0, s62, 98304
    s_waitcnt vmcnt(6)
    s_cbranch_vccnz L_t_21
    s_waitcnt vmcnt(5)
L_t_21:
    buffer_load_dwordx4 v4, s[40:43], s60 offen offset:0 nt lds
    s_waitcnt vmcnt(6)
    s_cbranch_vccnz L_t_22
    s_waitcnt vmcnt(5)
L_t_22:
    buffer_load_dwordx4 v5, s[40:43], s60 offen offset:1024 nt lds
    s_waitcnt vmcnt(6)
    s_cbranch_vccnz L_t_23
    s_waitcnt vmcnt(5)
L_t_23:
    buffer_load_dwordx4 v6, s[40:43], s60 offen offset:2048 nt lds
    s_waitcnt vmcnt(6)
    s_cbranch_vccnz L_t_24
    s_waitcnt vmcnt(5)
L_t_24:
    buffer_load_dwordx4 v7, s[40:43], s60 offen offset:3072 nt lds
    s_add_u32 m0, s62, 114688
    s_waitcnt vmcnt(6)
    s_cbranch_vccnz L_t_25
    s_waitcnt vmcnt(5)
L_t_25:
    buffer_load_dwordx4 v4, s[40:43], s61 offen offset:0 nt lds
    s_waitcnt vmcnt(6)
    s_cbranch_vccnz L_t_26
    s_waitcnt vmcnt(5)
L_t_26:
    buffer_load_dwordx4 v5, s[40:43], s61 offen offset:1024 nt lds
    s_waitcnt vmcnt(6)
    s_cbranch_vccnz L_t_27
    s_waitcnt vmcnt(5)
L_t_27:
    buffer_load_dwordx4 v6, s[40:43], s61 offen offset:2048 nt lds
    s_waitcnt vmcnt(6)
    s_cbranch_vccnz L_t_28
    s_waitcnt vmcnt(5)
L_t_28:
    buffer_load_dwordx4 v7, s[40:43], s61 offen offset:3072 nt lds
    v_add_u32 v8, 0x10000, v8
    v_add_u32 v9, 0x10000, v9
    v_add_u32 v10, 0x10000, v10
    v_add_u32 v11, 0x10000, v11
    s_waitcnt vmcnt(8) lgkmcnt(0)
    ds_read_b128 v[192:195], v8 offset:0
    ds_read_b128 v[196:199], v9 offset:0
    ds_read_b128 v[200:203], v10 offset:0
    ds_read_b128 v[204:207], v11 offset:0
    ds_read_b128 v[208:211], v8 offset:256
    ds_read_b128 v[212:215], v9 offset:256
    ds_read_b128 v[216:219], v10 offset:256
    ds_read_b128 v[220:223], v11 offset:256
    s_add_u32 m0, s62, 0
    s_waitcnt vmcnt(5)
    buffer_load_dwordx4 v4, s[44:47], s54 offen offset:0 nt lds
    v_mov_b32 v12, 163360
    v_mov_b32 v13, 1
    ds_write_b32 v12, v13
    s_waitcnt vmcnt(5)
    buffer_load_dwordx4 v5, s[44:47], s54 offen offset:1024 nt lds
    s_waitcnt vmcnt(5)
    buffer_load_dwordx4 v6, s[44:47], s54 offen offset:2048 nt lds
    s_waitcnt vmcnt(5)
    buffer_load_dwordx4 v7, s[44:47], s54 offen offset:3072 nt lds
    s_add_u32 m0, s62, 16384
    s_waitcnt vmcnt(5)
    buffer_load_dwordx4 v4, s[44:47], s55 offen offset:0 nt lds
    s_waitcnt vmcnt(5)
    buffer_load_dwordx4 v5, s[44:47], s55 offen offset:1024 nt lds
    s_waitcnt vmcnt(5)
    buffer_load_dwordx4 v6, s[44:47], s55 offen offset:2048 nt lds
    s_waitcnt vmcnt(5)
    buffer_load_dwordx4 v7, s[44:47], s55 offen offset:3072 nt lds
    s_waitcnt vmcnt(8) lgkmcnt(0)
    ds_read_b128 v[224:227], v8 offset:32768
    ds_read_b128 v[228:231], v9 offset:32768
    ds_read_b128 v[232:235], v10 offset:32768
    ds_read_b128 v[236:239], v11 offset:32768
    ds_read_b128 v[240:243], v8 offset:33024
    ds_read_b128 v[244:247], v9 offset:33024
    ds_read_b128 v[248:251], v10 offset:33024
    ds_read_b128 v[252:255], v11 offset:33024
    s_add_u32 m0, s62, 32768
    s_waitcnt vmcnt(5)
    buffer_load_dwordx4 v4, s[44:47], s56 offen offset:0 nt lds
    s_waitcnt vmcnt(5)
    buffer_load_dwordx4 v5, s[44:47], s56 offen offset:1024 nt lds
    s_waitcnt vmcnt(5)
    buffer_load_dwordx4 v6, s[44:47], s56 offen offset:2048 nt lds
    s_waitcnt vmcnt(5)
    buffer_load_dwordx4 v7, s[44:47], s56 offen offset:3072 nt lds
    s_add_u32 m0, s62, 49152
    s_waitcnt vmcnt(5)
    buffer_load_dwordx4 v4, s[44:47], s57 offen offset:0 nt lds
    s_waitcnt vmcnt(5)
    buffer_load_dwordx4 v5, s[44:47], s57 offen offset:1024 nt lds
    s_waitcnt vmcnt(5)
    buffer_load_dwordx4 v6, s[44:47], s57 offen offset:2048 nt lds
    s_waitcnt vmcnt(5)
    buffer_load_dwordx4 v7, s[44:47], s57 offen offset:3072 nt lds
    s_waitcnt lgkmcnt(0)
    s_add_u32 m0, s62, 65536
    s_nop 0
    buffer_load_dwordx4 v4, s[44:47], s58 offen offset:0 nt lds
    buffer_load_dwordx4 v5, s[44:47], s58 offen offset:1024 nt lds
    buffer_load_dwordx4 v6, s[44:47], s58 offen offset:2048 nt lds
    buffer_load_dwordx4 v7, s[44:47], s58 offen offset:3072 nt lds
    v_and_b32 v12, 1, v2
    v_lshlrev_b32 v13, 9, v12
    v_lshl_add_u32 v13, v1, 4, v13
    v_add_u32 v13, 160768, v13
    s_and_b32 s34, s34, 0xff
    s_mul_i32 s34, s34, 0x01010101
    s_xor_b32 s35, s34, 0x9e3779b9
    s_and_b32 s35, s35, 0x80808080
    s_and_b32 s34, s34, 0x7f7f7f7f
    s_add_u32 s34, s34, 0x1e377939
    s_xor_b32 s34, s34, s35
    s_mov_b32 s64, 0xc0c0c0c
    s_mov_b32 s65, 0xc0c0c0c
    s_mov_b32 s66, 0x30303030
    s_mov_b32 s67, 0x30303030
    s_mov_b32 s68, 0xc0c0c0c0
    s_mov_b32 s69, 0xc0c0c0c0
    v_lshlrev_b32 v14, 6, v12
    v_add_u32 v14, 162848, v14
    s_lshl_b32 s63, s3, 4
    v_lshl_add_u32 v15, v1, 2, v14
    v_add_u32 v15, s63, v15
    v_bfe_u32 v32, v2, 1, 2
    v_lshlrev_b32 v32, 7, v32
    v_lshrrev_b32 v33, 1, v1
    v_lshl_add_u32 v32, v33, 6, v32
    v_and_b32 v33, 1, v1
    v_lshl_add_u32 v32, v33, 4, v32
    v_mul_u32_u24 v33, 528, v12
    s_lshr_b32 s63, s3, 1
    s_lshl_b32 s63, s63, 5
    s_and_b32 s70, s3, 1
    s_lshl_b32 s70, s70, 3
    s_add_u32 s63, s63, s70
    s_add_u32 s63, s63, 161792
    v_add3_u32 v32, v32, v33, s63
    s_waitcnt vmcnt(12)
    s_barrier
    ds_read_b128 v[96:99], v13 offset:0
    ds_read_b128 v[100:103], v13 offset:64
    ds_read_b128 v[104:107], v13 offset:128
    ds_read_b128 v[108:111], v13 offset:192
    ds_read_b128 v[112:115], v13 offset:256
    ds_read_b128 v[116:119], v13 offset:320
    ds_read_b128 v[120:123], v13 offset:384
    ds_read_b128 v[124:127], v13 offset:448
    s_add_u32 m0, s62, 81920
    s_nop 0
    buffer_load_dwordx4 v4, s[44:47], s59 offen offset:0 nt lds
    buffer_load_dwordx4 v5, s[44:47], s59 offen offset:1024 nt lds
    buffer_load_dwordx4 v6, s[44:47], s59 offen offset:2048 nt lds
    buffer_load_dwordx4 v7, s[44:47], s59 offen offset:3072 nt lds
    s_waitcnt lgkmcnt(7)
    v_mfma_f32_16x16x32_bf16 v[16:19], v[128:131], v[96:99], 0
    v_mfma_f32_16x16x32_bf16 v[20:23], v[160:163], v[96:99], 0
    v_mfma_f32_16x16x32_bf16 v[24:27], v[192:195], v[96:99], 0
    v_mfma_f32_16x16x32_bf16 v[28:31], v[224:227], v[96:99], 0
    s_waitcnt lgkmcnt(6)
    v_mfma_f32_16x16x32_bf16 v[16:19], v[132:135], v[100:103], v[16:19]
    v_mfma_f32_16x16x32_bf16 v[20:23], v[164:167], v[100:103], v[20:23]
    v_mfma_f32_16x16x32_bf16 v[24:27], v[196:199], v[100:103], v[24:27]
    v_mfma_f32_16x16x32_bf16 v[28:31], v[228:231], v[100:103], v[28:31]
    s_waitcnt lgkmcnt(5)
    v_mfma_f32_16x16x32_bf16 v[16:19], v[136:139], v[104:107], v[16:19]
    v_mfma_f32_16x16x32_bf16 v[20:23], v[168:171], v[104:107], v[20:23]
    v_mfma_f32_16x16x32_bf16 v[24:27], v[200:203], v[104:107], v[24:27]
    v_mfma_f32_16x16x32_bf16 v[28:31], v[232:235], v[104:107], v[28:31]
    s_waitcnt lgkmcnt(4)
    v_mfma_f32_16x16x32_bf16 v[16:19], v[140:143], v[108:111], v[16:19]
    v_mfma_f32_16x16x32_bf16 v[20:23], v[172:175], v[108:111], v[20:23]
    v_mfma_f32_16x16x32_bf16 v[24:27], v[204:207], v[108:111], v[24:27]
    v_mfma_f32_16x16x32_bf16 v[28:31], v[236:239], v[108:111], v[28:31]
    s_waitcnt lgkmcnt(3)
    v_mfma_f32_16x16x32_bf16 v[16:19], v[144:147], v[112:115], v[16:19]
    v_mfma_f32_16x16x32_bf16 v[20:23], v[176:179], v[112:115], v[20:23]
    v_mfma_f32_16x16x32_bf16 v[24:27], v[208:211], v[112:115], v[24:27]
    v_mfma_f32_16x16x32_bf16 v[28:31], v[240:243], v[112:115], v[28:31]
    s_waitcnt lgkmcnt(2)
    v_mfma_f32_16x16x32_bf16 v[16:19], v[148:151], v[116:119], v[16:19]
    v_mfma_f32_16x16x32_bf16 v[20:23], v[180:183], v[116:119], v[20:23]
    v_mfma_f32_16x16x32_bf16 v[24:27], v[212:215], v[116:119], v[24:27]
    v_mfma_f32_16x16x32_bf16 v[28:31], v[244:247], v[116:119], v[28:31]
    s_waitcnt lgkmcnt(1)
    v_mfma_f32_16x16x32_bf16 v[16:19], v[152:155], v[120:123], v[16:19]
    v_mfma_f32_16x16x32_bf16 v[20:23], v[184:187], v[120:123], v[20:23]
    v_mfma_f32_16x16x32_bf16 v[24:27], v[216:219], v[120:123], v[24:27]
    v_mfma_f32_16x16x32_bf16 v[28:31], v[248:251], v[120:123], v[28:31]
    s_waitcnt lgkmcnt(0)
    v_mfma_f32_16x16x32_bf16 v[16:19], v[156:159], v[124:127], v[16:19]
    v_mfma_f32_16x16x32_bf16 v[20:23], v[188:191], v[124:127], v[20:23]
    v_mfma_f32_16x16x32_bf16 v[24:27], v[220:223], v[124:127], v[24:27]
    v_mfma_f32_16x16x32_bf16 v[28:31], v[252:255], v[124:127], v[28:31]
    s_nop 5
    v_cndmask_b32 v16, v16, v20, s[64:65]
    v_cndmask_b32 v17, v17, v21, s[64:65]
    v_cndmask_b32 v18, v18, v22, s[64:65]
    v_cndmask_b32 v19, v19, v23, s[64:65]
    v_cndmask_b32 v16, v16, v24, s[66:67]
    v_cndmask_b32 v17, v17, v25, s[66:67]
    v_cndmask_b32 v18, v18, v26, s[66:67]
    v_cndmask_b32 v19, v19, v27, s[66:67]
    v_cndmask_b32 v16, v16, v28, s[68:69]
    v_cndmask_b32 v17, v17, v29, s[68:69]
    v_cndmask_b32 v18, v18, v30, s[68:69]
    v_cndmask_b32 v19, v19, v31, s[68:69]
    v_cvt_pk_bf16_f32 v20, v16, v17
    v_lshlrev_b32 v16, 16, v20
    v_and_b32 v17, 0xffff0000, v20
    v_cvt_pk_bf16_f32 v21, v18, v19
    v_lshlrev_b32 v18, 16, v21
    v_and_b32 v19, 0xffff0000, v21
    v_max3_f32 v20, v16, v17, v18
    v_max_f32 v20, v20, v19
    s_nop 1
    v_max_f32_dpp v20, v20, v20 row_ror:2 row_mask:0xf bank_mask:0xf
    s_nop 1
    v_max_f32_dpp v20, v20, v20 row_ror:4 row_mask:0xf bank_mask:0xf
    ds_write_b32 v15, v20
    s_waitcnt lgkmcnt(0)
    s_barrier
    ds_read_b128 v[36:39], v14 offset:0
    ds_read_b128 v[40:43], v14 offset:16
    ds_read_b128 v[44:47], v14 offset:32
    ds_read_b128 v[48:51], v14 offset:48
    s_mov_b32 s63, 0x3db8aa3b
    s_waitcnt lgkmcnt(2)
    v_max3_f32 v20, v36, v37, v38
    v_max3_f32 v21, v39, v40, v41
    v_max3_f32 v20, v20, v42, v43
    s_waitcnt lgkmcnt(0)
    v_max3_f32 v21, v21, v44, v45
    v_max3_f32 v20, v20, v46, v47
    v_max3_f32 v21, v21, v48, v49
    v_max3_f32 v20, v20, v50, v51
    v_max_f32 v20, v20, v21
    v_sub_f32 v16, v16, v20
    v_sub_f32 v17, v17, v20
    v_sub_f32 v18, v18, v20
    v_sub_f32 v19, v19, v20
    v_mul_f32 v16, s63, v16
    v_mul_f32 v17, s63, v17
    v_mul_f32 v18, s63, v18
    v_mul_f32 v19, s63, v19
    v_exp_f32 v16, v16
    v_exp_f32 v17, v17
    v_exp_f32 v18, v18
    v_exp_f32 v19, v19
    v_add_f32 v20, v16, v17
    v_cvt_pk_bf16_f32 v22, v16, v17
    v_add_f32 v21, v18, v19
    v_cvt_pk_bf16_f32 v23, v18, v19
    v_add_f32 v20, v20, v21
    ds_write_b64 v32, v[22:23]
    s_nop 0
    v_add_f32_dpp v20, v20, v20 row_ror:2 row_mask:0xf bank_mask:0xf
    s_nop 1
    v_add_f32_dpp v20, v20, v20 row_ror:4 row_mask:0xf bank_mask:0xf
    ds_write_b32 v15, v20 offset:128
    s_waitcnt vmcnt(8) lgkmcnt(0)
    s_barrier
    s_cmp_eq_u32 s3, 3
    s_cbranch_scc0 L_nostat
    v_lshlrev_b32 v44, 6, v12
    v_lshrrev_b32 v45, 1, v2
    v_lshl_add_u32 v44, v45, 3, v44
    v_add_u32 v44, 162848, v44
    ds_read_b64 v[40:41], v44
    ds_read_b64 v[42:43], v44 offset:128
    s_lshl_b32 s64, s4, 5
    s_lshl_b32 s65, s6, 4
    s_add_u32 s64, s64, s65
    s_add_u32 s64, s64, s7
    s_lshl_b32 s64, s64, 7
    s_add_u32 s64, s64, 106496
    v_lshlrev_b32 v45, 4, v0
    s_waitcnt lgkmcnt(0)
    v_max_f32 v40, v40, v41
    v_add_f32 v42, v42, v43
    v_mov_b32 v41, s34
    v_mov_b32 v43, s34
    v_max_f32_dpp v40, v40, v40 row_ror:2 row_mask:0xf bank_mask:0xf
    v_add_f32_dpp v42, v42, v42 row_ror:2 row_mask:0xf bank_mask:0xf
    s_nop 0
    v_max_f32_dpp v40, v40, v40 row_ror:4 row_mask:0xf bank_mask:0xf
    v_add_f32_dpp v42, v42, v42 row_ror:4 row_mask:0xf bank_mask:0xf
    s_nop 0
    v_max_f32_dpp v40, v40, v40 row_ror:8 row_mask:0xf bank_mask:0xf
    v_add_f32_dpp v42, v42, v42 row_ror:8 row_mask:0xf bank_mask:0xf
    s_mov_b64 exec, 15
    buffer_store_dwordx4 v[40:43], v45, s[36:39], s64 offen
    s_mov_b64 exec, -1
L_nostat:
    s_add_u32 m0, s62, 98304
    s_waitcnt vmcnt(4)
    buffer_load_dwordx4 v4, s[44:47], s60 offen offset:0 nt lds
    s_waitcnt vmcnt(4)
    buffer_load_dwordx4 v5, s[44:47], s60 offen offset:1024 nt lds
    s_waitcnt vmcnt(4)
    buffer_load_dwordx4 v6, s[44:47], s60 offen offset:2048 nt lds
    s_waitcnt vmcnt(4)
    buffer_load_dwordx4 v7, s[44:47], s60 offen offset:3072 nt lds
    s_add_u32 m0, s62, 114688
    s_waitcnt vmcnt(4)
    buffer_load_dwordx4 v4, s[44:47], s61 offen offset:0 nt lds
    s_waitcnt vmcnt(4)
    buffer_load_dwordx4 v5, s[44:47], s61 offen offset:1024 nt lds
    s_waitcnt vmcnt(6)
    s_barrier
    s_waitcnt vmcnt(4)
    buffer_load_dwordx4 v6, s[44:47], s61 offen offset:2048 nt lds
    s_waitcnt vmcnt(4)
    buffer_load_dwordx4 v7, s[44:47], s61 offen offset:3072 nt lds
    s_cmp_lt_u32 s5, 14
    s_cbranch_scc1 L_WX
    s_cmp_lt_u32 s5, 28
    s_cbranch_scc1 L_FX
    s_waitcnt vmcnt(4)
    s_barrier
    s_waitcnt vmcnt(0)
    s_barrier
    s_barrier
    s_sub_u32 s52, s5, 28
    s_lshl_b32 s52, s52, 1
    s_lshr_b32 s53, s3, 1
    s_add_u32 s52, s52, s53
    s_mul_i32 s52, s52, 200704
    s_mul_i32 s53, s4, 448
    s_and_b32 s53, s53, -128
    s_add_u32 s52, s52, s53
    s_sub_u32 s54, 384, s53
    s_and_b32 s54, s54, 384
    s_bitcmp1_b32 s4, 0
    s_cselect_b32 s53, 0, 384
    s_mov_b32 s53, s54
    s_bitcmp1_b32 s3, 0
    s_cselect_b32 s100, s22, s20
    s_cselect_b32 s101, s23, s21
    v_min_u32 v4, 55, v0
    v_mul_u32_u24 v4, 3584, v4
    v_add_u32 v4, s52, v4
    s_xor_b32 s54, s53, 0
    v_add_u32 v5, s54, v4
    global_load_dword v8, v5, s[100:101]
    s_branch L_done
L_X:
    s_setprio 3
    s_barrier
    s_cmp_ge_u32 s3, 6
    s_cbranch_scc1 L_X23
    s_mov_b32 s64, 0xffffffff
    s_mov_b32 s65, 0xffffff
    s_mov_b32 s40, s26
    s_mov_b32 s41, s27
    s_mov_b32 s42, 1792
    s_mov_b32 s43, 0x20000
    s_mov_b32 s44, s8
    s_mov_b32 s45, s9
    s_mov_b32 s46, 1792
    s_mov_b32 s47, 0x20000
    v_lshlrev_b32 v4, 4, v0
    v_lshlrev_b32 v5, 3, v0
    v_mov_b32 v6, 0x1000000
    v_cndmask_b32 v4, v6, v4, s[64:65]
    v_cndmask_b32 v5, v6, v5, s[64:65]
    s_mul_i32 s52, s71, 896
    s_mul_i32 s53, s69, 448
    s_add_u32 s53, s53, s52
    buffer_load_dwordx2 v[8:9], v5, s[40:43], s53 offen
    buffer_load_dwordx2 v[10:11], v5, s[44:47], s53 offen
    buffer_load_dwordx4 v[12:15], v4, s[44:47], s52 offen
    v_and_b32 v16, 1, v1
    v_lshrrev_b32 v17, 3, v2
    v_lshl_add_u32 v17, v16, 1, v17
    v_lshlrev_b32 v17, 5, v17
    v_lshl_add_u32 v17, v16, 9, v17
    v_lshrrev_b32 v16, 1, v1
    v_lshl_add_u32 v17, v16, 11, v17
    v_lshrrev_b32 v16, 2, v2
    v_lshl_add_u32 v17, v16, 7, v17
    v_and_b32 v16, 3, v2
    v_lshl_add_u32 v17, v16, 3, v17
    v_add_u32 v16, 131072, v17
    v_xor_b32 v17, 32, v16
    v_xor_b32 v18, 64, v16
    v_xor_b32 v19, 96, v16
    s_lshl_b32 s54, s71, 9
    s_add_u32 s54, s54, 159744
    v_and_b32 v20, 0x7c, v0
    v_lshlrev_b32 v20, 3, v20
    v_bfe_u32 v62, v0, 1, 1
    v_lshl_add_u32 v20, v62, 3, v20
    v_and_b32 v62, 1, v0
    v_lshl_add_u32 v20, v62, 4, v20
    v_add_u32 v20, s54, v20
    v_lshlrev_b32 v21, 4, v1
    v_add_u32 v21, s54, v21
    v_mov_b32 v60, 163360
    v_mov_b32 v61, 1
    s_waitcnt vmcnt(0) lgkmcnt(0)
    s_and_b32 s34, s34, 0xff
    s_mul_i32 s34, s34, 0x01010101
    s_xor_b32 s35, s34, 0x9e3779b9
    s_and_b32 s35, s35, 0x80808080
    s_and_b32 s34, s34, 0x7f7f7f7f
    s_add_u32 s34, s34, 0x1e377939
    s_xor_b32 s34, s34, s35
    s_mov_b64 exec, 1
    ds_add_u32 v60, v61 offset:12
    s_mov_b64 exec, -1
    s_cmp_eq_u32 s70, 0
    s_cbranch_scc1 L_XB1
    s_mov_b32 s57, 0
L_tile_wait:
    ds_read_b32 v61, v60 offset:12
    s_waitcnt lgkmcnt(0)
    v_cmp_ne_u32 vcc, 8, v61
    s_cbranch_vccz L_tile_go
    s_add_u32 s57, s57, 1
    s_cmp_lt_u32 s57, 65536
    s_cbranch_scc1 L_tile_wait
L_tile_go:
    s_cmp_eq_u32 s70, 1
    s_cbranch_scc1 L_X01_q
    s_mov_b32 s57, 0xbfb8aa3b
    v_lshlrev_b32 v24, 16, v8
    v_and_b32 v25, 0xffff0000, v8
    v_lshlrev_b32 v26, 16, v9
    v_and_b32 v27, 0xffff0000, v9
    v_mul_f32 v28, s57, v24
    v_mul_f32 v29, s57, v25
    v_mul_f32 v30, s57, v26
    v_mul_f32 v31, s57, v27
    v_exp_f32 v28, v28
    v_exp_f32 v29, v29
    v_exp_f32 v30, v30
    v_exp_f32 v31, v31
    v_add_f32 v28, 1.0, v28
    v_add_f32 v29, 1.0, v29
    v_add_f32 v30, 1.0, v30
    v_add_f32 v31, 1.0, v31
    v_rcp_f32 v28, v28
    v_rcp_f32 v29, v29
    v_rcp_f32 v30, v30
    v_rcp_f32 v31, v31
    v_mul_f32 v24, v24, v28
    v_mul_f32 v25, v25, v29
    v_mul_f32 v26, v26, v30
    v_mul_f32 v27, v27, v31
    ds_read_b64_tr_b16 v[128:129], v16 offset:0
    ds_read_b64_tr_b16 v[130:131], v16 offset:1024
    ds_read_b64_tr_b16 v[132:133], v17 offset:0
    ds_read_b64_tr_b16 v[134:135], v17 offset:1024
    ds_read_b64_tr_b16 v[136:137], v18 offset:0
    ds_read_b64_tr_b16 v[138:139], v18 offset:1024
    ds_read_b64_tr_b16 v[140:141], v19 offset:0
    ds_read_b64_tr_b16 v[142:143], v19 offset:1024
    s_waitcnt lgkmcnt(7)
    ds_read_b64_tr_b16 v[144:145], v16 offset:4096
    ds_read_b64_tr_b16 v[146:147], v16 offset:5120
    ds_read_b64_tr_b16 v[148:149], v17 offset:4096
    ds_read_b64_tr_b16 v[150:151], v17 offset:5120
    ds_read_b64_tr_b16 v[152:153], v18 offset:4096
    ds_read_b64_tr_b16 v[154:155], v18 offset:5120
    ds_read_b64_tr_b16 v[156:157], v19 offset:4096
    ds_read_b64_tr_b16 v[158:159], v19 offset:5120
    s_waitcnt lgkmcnt(7)
    ds_read_b64_tr_b16 v[160:161], v16 offset:8192
    ds_read_b64_tr_b16 v[162:163], v16 offset:9216
    ds_read_b64_tr_b16 v[164:165], v17 offset:8192
    ds_read_b64_tr_b16 v[166:167], v17 offset:9216
    ds_read_b64_tr_b16 v[168:169], v18 offset:8192
    ds_read_b64_tr_b16 v[170:171], v18 offset:9216
    ds_read_b64_tr_b16 v[172:173], v19 offset:8192
    ds_read_b64_tr_b16 v[174:175], v19 offset:9216
    s_waitcnt lgkmcnt(7)
    ds_read_b64_tr_b16 v[176:177], v16 offset:12288
    ds_read_b64_tr_b16 v[178:179], v16 offset:13312
    ds_read_b64_tr_b16 v[180:181], v17 offset:12288
    ds_read_b64_tr_b16 v[182:183], v17 offset:13312
    ds_read_b64_tr_b16 v[184:185], v18 offset:12288
    ds_read_b64_tr_b16 v[186:187], v18 offset:13312
    ds_read_b64_tr_b16 v[188:189], v19 offset:12288
    ds_read_b64_tr_b16 v[190:191], v19 offset:13312
    s_waitcnt lgkmcnt(7)
    ds_read_b64_tr_b16 v[192:193], v16 offset:16384
    ds_read_b64_tr_b16 v[194:195], v16 offset:17408
    ds_read_b64_tr_b16 v[196:197], v17 offset:16384
    ds_read_b64_tr_b16 v[198:199], v17 offset:17408
    ds_read_b64_tr_b16 v[200:201], v18 offset:16384
    ds_read_b64_tr_b16 v[202:203], v18 offset:17408
    ds_read_b64_tr_b16 v[204:205], v19 offset:16384
    ds_read_b64_tr_b16 v[206:207], v19 offset:17408
    s_waitcnt lgkmcnt(7)
    ds_read_b64_tr_b16 v[208:209], v16 offset:20480
    ds_read_b64_tr_b16 v[210:211], v16 offset:21504
    ds_read_b64_tr_b16 v[212:213], v17 offset:20480
    ds_read_b64_tr_b16 v[214:215], v17 offset:21504
    ds_read_b64_tr_b16 v[216:217], v18 offset:20480
    ds_read_b64_tr_b16 v[218:219], v18 offset:21504
    ds_read_b64_tr_b16 v[220:221], v19 offset:20480
    ds_read_b64_tr_b16 v[222:223], v19 offset:21504
    s_waitcnt lgkmcnt(7)
    ds_read_b64_tr_b16 v[224:225], v16 offset:24576
    ds_read_b64_tr_b16 v[226:227], v16 offset:25600
    ds_read_b64_tr_b16 v[228:229], v17 offset:24576
    ds_read_b64_tr_b16 v[230:231], v17 offset:25600
    ds_read_b64_tr_b16 v[232:233], v18 offset:24576
    ds_read_b64_tr_b16 v[234:235], v18 offset:25600
    ds_read_b64_tr_b16 v[236:237], v19 offset:24576
    ds_read_b64_tr_b16 v[238:239], v19 offset:25600
    s_waitcnt lgkmcnt(7)
    s_lshl_b32 s55, s69, 1
    s_add_u32 s55, s55, s71
    s_mul_i32 s55, s55, 10752
    s_add_u32 s55, s55, 4096
    s_branch L_X01_mm
L_X01_q:
    ds_read_b64_tr_b16 v[128:129], v16 offset:0
    ds_read_b64_tr_b16 v[130:131], v16 offset:1024
    ds_read_b64_tr_b16 v[132:133], v17 offset:0
    ds_read_b64_tr_b16 v[134:135], v17 offset:1024
    ds_read_b64_tr_b16 v[136:137], v18 offset:0
    ds_read_b64_tr_b16 v[138:139], v18 offset:1024
    ds_read_b64_tr_b16 v[140:141], v19 offset:0
    ds_read_b64_tr_b16 v[142:143], v19 offset:1024
    s_waitcnt lgkmcnt(7)
    ds_read_b64_tr_b16 v[144:145], v16 offset:4096
    ds_read_b64_tr_b16 v[146:147], v16 offset:5120
    ds_read_b64_tr_b16 v[148:149], v17 offset:4096
    ds_read_b64_tr_b16 v[150:151], v17 offset:5120
    ds_read_b64_tr_b16 v[152:153], v18 offset:4096
    ds_read_b64_tr_b16 v[154:155], v18 offset:5120
    ds_read_b64_tr_b16 v[156:157], v19 offset:4096
    ds_read_b64_tr_b16 v[158:159], v19 offset:5120
    s_waitcnt lgkmcnt(7)
    ds_read_b64_tr_b16 v[160:161], v16 offset:8192
    ds_read_b64_tr_b16 v[162:163], v16 offset:9216
    ds_read_b64_tr_b16 v[164:165], v17 offset:8192
    ds_read_b64_tr_b16 v[166:167], v17 offset:9216
    ds_read_b64_tr_b16 v[168:169], v18 offset:8192
    ds_read_b64_tr_b16 v[170:171], v18 offset:9216
    ds_read_b64_tr_b16 v[172:173], v19 offset:8192
    ds_read_b64_tr_b16 v[174:175], v19 offset:9216
    s_waitcnt lgkmcnt(7)
    ds_read_b64_tr_b16 v[176:177], v16 offset:12288
    ds_read_b64_tr_b16 v[178:179], v16 offset:13312
    ds_read_b64_tr_b16 v[180:181], v17 offset:12288
    ds_read_b64_tr_b16 v[182:183], v17 offset:13312
    ds_read_b64_tr_b16 v[184:185], v18 offset:12288
    ds_read_b64_tr_b16 v[186:187], v18 offset:13312
    ds_read_b64_tr_b16 v[188:189], v19 offset:12288
    ds_read_b64_tr_b16 v[190:191], v19 offset:13312
    s_waitcnt lgkmcnt(7)
    ds_read_b64_tr_b16 v[192:193], v16 offset:16384
    ds_read_b64_tr_b16 v[194:195], v16 offset:17408
    ds_read_b64_tr_b16 v[196:197], v17 offset:16384
    ds_read_b64_tr_b16 v[198:199], v17 offset:17408
    ds_read_b64_tr_b16 v[200:201], v18 offset:16384
    ds_read_b64_tr_b16 v[202:203], v18 offset:17408
    ds_read_b64_tr_b16 v[204:205], v19 offset:16384
    ds_read_b64_tr_b16 v[206:207], v19 offset:17408
    s_waitcnt lgkmcnt(7)
    ds_read_b64_tr_b16 v[208:209], v16 offset:20480
    ds_read_b64_tr_b16 v[210:211], v16 offset:21504
    ds_read_b64_tr_b16 v[212:213], v17 offset:20480
    ds_read_b64_tr_b16 v[214:215], v17 offset:21504
    ds_read_b64_tr_b16 v[216:217], v18 offset:20480
    ds_read_b64_tr_b16 v[218:219], v18 offset:21504
    ds_read_b64_tr_b16 v[220:221], v19 offset:20480
    ds_read_b64_tr_b16 v[222:223], v19 offset:21504
    s_waitcnt lgkmcnt(7)
    ds_read_b64_tr_b16 v[224:225], v16 offset:24576
    ds_read_b64_tr_b16 v[226:227], v16 offset:25600
    ds_read_b64_tr_b16 v[228:229], v17 offset:24576
    ds_read_b64_tr_b16 v[230:231], v17 offset:25600
    ds_read_b64_tr_b16 v[232:233], v18 offset:24576
    ds_read_b64_tr_b16 v[234:235], v18 offset:25600
    ds_read_b64_tr_b16 v[236:237], v19 offset:24576
    ds_read_b64_tr_b16 v[238:239], v19 offset:25600
    s_waitcnt lgkmcnt(7)
    v_lshlrev_b32 v32, 16, v12
    v_and_b32 v33, 0xffff0000, v12
    v_lshlrev_b32 v34, 16, v13
    v_and_b32 v35, 0xffff0000, v13
    v_lshlrev_b32 v36, 16, v14
    v_and_b32 v37, 0xffff0000, v14
    v_lshlrev_b32 v38, 16, v15
    v_and_b32 v39, 0xffff0000, v15
    v_pk_add_f32 v[40:41], v[32:33], v[34:35]
    v_pk_add_f32 v[42:43], v[36:37], v[38:39]
    v_pk_add_f32 v[40:41], v[40:41], v[42:43]
    v_add_f32 v40, v40, v41
    s_nop 1
    v_add_f32_dpp v40, v40, v40 row_ror:8 row_mask:0xf bank_mask:0xf
    s_nop 1
    v_add_f32_dpp v40, v40, v40 row_ror:4 row_mask:0xf bank_mask:0xf
    s_nop 1
    v_add_f32_dpp v40, v40, v40 row_ror:2 row_mask:0xf bank_mask:0xf
    s_nop 1
    v_add_f32_dpp v40, v40, v40 row_ror:1 row_mask:0xf bank_mask:0xf
    s_nop 1
    v_add_f32_dpp v40, v40, v40 row_bcast:15 row_mask:0xa bank_mask:0xf
    s_nop 1
    v_add_f32_dpp v40, v40, v40 row_bcast:31 row_mask:0xc bank_mask:0xf
    v_mul_f32 v40, 0x3b124925, v40
    s_nop 0
    v_readlane_b32 s58, v40, 63
    s_nop 1
    v_subrev_f32 v32, s58, v32
    v_subrev_f32 v33, s58, v33
    v_subrev_f32 v34, s58, v34
    v_subrev_f32 v35, s58, v35
    v_subrev_f32 v36, s58, v36
    v_subrev_f32 v37, s58, v37
    v_subrev_f32 v38, s58, v38
    v_subrev_f32 v39, s58, v39
    v_pk_mul_f32 v[42:43], v[32:33], v[32:33]
    v_pk_fma_f32 v[42:43], v[34:35], v[34:35], v[42:43]
    v_pk_fma_f32 v[42:43], v[36:37], v[36:37], v[42:43]
    v_pk_fma_f32 v[42:43], v[38:39], v[38:39], v[42:43]
    v_add_f32 v42, v42, v43
    v_cndmask_b32 v42, 0, v42, s[64:65]
    s_nop 1
    v_add_f32_dpp v42, v42, v42 row_ror:8 row_mask:0xf bank_mask:0xf
    s_nop 1
    v_add_f32_dpp v42, v42, v42 row_ror:4 row_mask:0xf bank_mask:0xf
    s_nop 1
    v_add_f32_dpp v42, v42, v42 row_ror:2 row_mask:0xf bank_mask:0xf
    s_nop 1
    v_add_f32_dpp v42, v42, v42 row_ror:1 row_mask:0xf bank_mask:0xf
    s_nop 1
    v_add_f32_dpp v42, v42, v42 row_bcast:15 row_mask:0xa bank_mask:0xf
    s_nop 1
    v_add_f32_dpp v42, v42, v42 row_bcast:31 row_mask:0xc bank_mask:0xf
    v_mul_f32 v42, 0x3b124925, v42
    v_cvt_pk_bf16_f32 v41, v40, v42
    v_lshlrev_b32 v40, 16, v41
    v_and_b32 v42, 0xffff0000, v41
    v_add_f32 v42, 0x3727c5ac, v42
    v_readlane_b32 s58, v40, 63
    v_cvt_pk_bf16_f32 v42, v42, v42
    v_lshlrev_b32 v42, 16, v42
    v_sqrt_f32 v42, v42
    s_nop 0
    v_cvt_pk_bf16_f32 v42, v42, v42
    v_lshlrev_b32 v42, 16, v42
    v_rcp_f32 v42, v42
    v_lshlrev_b32 v32, 16, v10
    v_and_b32 v33, 0xffff0000, v10
    v_lshlrev_b32 v34, 16, v11
    v_and_b32 v35, 0xffff0000, v11
    v_readlane_b32 s59, v42, 63
    v_subrev_f32 v32, s58, v32
    v_subrev_f32 v33, s58, v33
    v_subrev_f32 v34, s58, v34
    v_subrev_f32 v35, s58, v35
    v_cvt_pk_bf16_f32 v36, v32, v33
    v_cvt_pk_bf16_f32 v37, v34, v35
    v_lshlrev_b32 v32, 16, v36
    v_and_b32 v33, 0xffff0000, v36
    v_lshlrev_b32 v34, 16, v37
    v_and_b32 v35, 0xffff0000, v37
    v_mul_f32 v32, s59, v32
    v_mul_f32 v33, s59, v33
    v_mul_f32 v34, s59, v34
    v_mul_f32 v35, s59, v35
    v_cvt_pk_bf16_f32 v36, v32, v33
    v_cvt_pk_bf16_f32 v37, v34, v35
    v_lshlrev_b32 v32, 16, v36
    v_and_b32 v33, 0xffff0000, v36
    v_lshlrev_b32 v34, 16, v37
    v_and_b32 v35, 0xffff0000, v37
    v_and_b32 v36, 3, v0
    v_lshlrev_b32 v36, 3, v36
    v_lshrrev_b32 v36, v36, s34
    v_lshrrev_b32 v37, 2, v36
    v_lshrrev_b32 v38, 4, v36
    v_lshrrev_b32 v39, 6, v36
    s_mov_b32 s57, 0
L_m_wait:
    s_sleep 2
    ds_read_b32 v61, v60 offset:8
    s_waitcnt lgkmcnt(0)
    v_cmp_ne_u32 vcc, 1, v61
    s_cbranch_vccz L_m_go
    s_add_u32 s57, s57, 1
    s_cmp_lt_u32 s57, 65536
    s_cbranch_scc1 L_m_wait
L_m_go:
    s_mul_i32 s55, s71, 10752
    s_mul_i32 s56, s69, 896
    s_add_u32 s55, s55, s56
    s_add_u32 s55, s55, 4096
    s_add_u32 s56, s55, 21504
    s_mov_b32 s57, 0
L_X01_poll:
    buffer_load_dwordx4 v[44:47], v4, s[36:39], s55 offen sc1
    buffer_load_dwordx4 v[48:51], v4, s[36:39], s56 offen sc1
    buffer_load_dwordx4 v[52:55], v4, s[36:39], s55 offen offset:1792 sc1
    buffer_load_dwordx4 v[56:59], v4, s[36:39], s56 offen offset:1792 sc1
    s_waitcnt vmcnt(3)
    v_xor_b32 v40, v44, v36
    v_bitop3_b32 v40, v40, v45, v37 bitop3:0xf6
    v_bitop3_b32 v40, v40, v46, v38 bitop3:0xf6
    v_bitop3_b32 v40, v40, v47, v39 bitop3:0xf6
    s_waitcnt vmcnt(2)
    v_bitop3_b32 v40, v40, v48, v36 bitop3:0xf6
    v_bitop3_b32 v40, v40, v49, v37 bitop3:0xf6
    v_bitop3_b32 v40, v40, v50, v38 bitop3:0xf6
    v_bitop3_b32 v40, v40, v51, v39 bitop3:0xf6
    s_waitcnt vmcnt(1)
    v_bitop3_b32 v40, v40, v52, v36 bitop3:0xf6
    v_bitop3_b32 v40, v40, v53, v37 bitop3:0xf6
    v_bitop3_b32 v40, v40, v54, v38 bitop3:0xf6
    v_bitop3_b32 v40, v40, v55, v39 bitop3:0xf6
    s_waitcnt vmcnt(0)
    v_bitop3_b32 v40, v40, v56, v36 bitop3:0xf6
    v_bitop3_b32 v40, v40, v57, v37 bitop3:0xf6
    v_bitop3_b32 v40, v40, v58, v38 bitop3:0xf6
    v_bitop3_b32 v40, v40, v59, v39 bitop3:0xf6
    v_and_b32 v40, 3, v40
    v_cmp_ne_u32 vcc, 0, v40
    s_and_b64 vcc, vcc, s[64:65]
    s_cbranch_vccz L_X01_got
    s_add_u32 s57, s57, 1
    s_and_b32 s35, s57, 127
    s_cbranch_scc1 L_nf_29
    buffer_wbl2 sc1
    s_waitcnt vmcnt(0)
L_nf_29:
    s_cmp_lt_u32 s57, 65536
    s_cbranch_scc1 L_X01_poll
L_X01_got:
    v_and_b32 v44, -4, v44
    v_and_b32 v45, -4, v45
    v_and_b32 v46, -4, v46
    v_and_b32 v47, -4, v47
    v_and_b32 v48, -4, v48
    v_and_b32 v49, -4, v49
    v_and_b32 v50, -4, v50
    v_and_b32 v51, -4, v51
    v_and_b32 v52, -4, v52
    v_and_b32 v53, -4, v53
    v_and_b32 v54, -4, v54
    v_and_b32 v55, -4, v55
    v_and_b32 v56, -4, v56
    v_and_b32 v57, -4, v57
    v_and_b32 v58, -4, v58
    v_and_b32 v59, -4, v59
    v_pk_add_f32 v[44:45], v[44:45], v[48:49]
    v_pk_add_f32 v[46:47], v[46:47], v[50:51]
    v_pk_add_f32 v[48:49], v[52:53], v[56:57]
    v_pk_add_f32 v[50:51], v[54:55], v[58:59]
    v_cvt_pk_bf16_f32 v52, v44, v45
    v_cvt_pk_bf16_f32 v53, v46, v47
    v_cvt_pk_bf16_f32 v54, v48, v49
    v_cvt_pk_bf16_f32 v55, v50, v51
    v_lshlrev_b32 v44, 16, v52
    v_and_b32 v45, 0xffff0000, v52
    v_lshlrev_b32 v46, 16, v53
    v_and_b32 v47, 0xffff0000, v53
    v_lshlrev_b32 v48, 16, v54
    v_and_b32 v49, 0xffff0000, v54
    v_lshlrev_b32 v50, 16, v55
    v_and_b32 v51, 0xffff0000, v55
    v_add_f32 v48, 1.0, v48
    v_add_f32 v49, 1.0, v49
    v_add_f32 v50, 1.0, v50
    v_add_f32 v51, 1.0, v51
    v_cvt_pk_bf16_f32 v52, v48, v49
    v_cvt_pk_bf16_f32 v53, v50, v51
    v_lshlrev_b32 v48, 16, v52
    v_and_b32 v49, 0xffff0000, v52
    v_lshlrev_b32 v50, 16, v53
    v_and_b32 v51, 0xffff0000, v53
    v_pk_mul_f32 v[48:49], v[48:49], v[32:33]
    v_pk_mul_f32 v[50:51], v[50:51], v[34:35]
    v_cvt_pk_bf16_f32 v52, v48, v49
    v_cvt_pk_bf16_f32 v53, v50, v51
    v_lshlrev_b32 v48, 16, v52
    v_and_b32 v49, 0xffff0000, v52
    v_lshlrev_b32 v50, 16, v53
    v_and_b32 v51, 0xffff0000, v53
    v_pk_add_f32 v[24:25], v[48:49], v[44:45]
    v_pk_add_f32 v[26:27], v[50:51], v[46:47]
    s_lshl_b32 s55, s69, 1
    s_add_u32 s55, s55, s71
    s_lshl_b32 s55, s55, 14
    s_add_u32 s55, s55, 147456
L_X01_mm:
    v_cvt_pk_bf16_f32 v28, v24, v25
    v_cvt_pk_bf16_f32 v29, v26, v27
    ds_write_b64 v20, v[28:29]
    s_lshl_b32 s56, s68, 8
    s_add_u32 s55, s55, s56
    v_lshlrev_b32 v22, 2, v0
    v_lshlrev_b32 v23, 1, v2
    v_lshrrev_b32 v23, v23, s34
    v_and_b32 v23, 3, v23
    s_waitcnt lgkmcnt(0)
    ds_read_b128 v[96:99], v21 offset:0
    ds_read_b128 v[100:103], v21 offset:64
    ds_read_b128 v[104:107], v21 offset:128
    ds_read_b128 v[108:111], v21 offset:192
    ds_read_b128 v[112:115], v21 offset:256
    ds_read_b128 v[116:119], v21 offset:320
    ds_read_b128 v[120:123], v21 offset:384
    s_mov_b32 s64, 0xffff0000
    s_mov_b32 s65, 0xffff0000
    s_mov_b32 s66, 0x0
    s_mov_b32 s67, 0xffffffff
    s_waitcnt lgkmcnt(6)
    v_mfma_f32_16x16x32_bf16 v[32:35], v[96:99], v[128:131], 0
    v_mfma_f32_16x16x32_bf16 v[36:39], v[96:99], v[132:135], 0
    v_mfma_f32_16x16x32_bf16 v[40:43], v[96:99], v[136:139], 0
    v_mfma_f32_16x16x32_bf16 v[44:47], v[96:99], v[140:143], 0
    s_waitcnt lgkmcnt(5)
    v_mfma_f32_16x16x32_bf16 v[32:35], v[100:103], v[144:147], v[32:35]
    v_mfma_f32_16x16x32_bf16 v[36:39], v[100:103], v[148:151], v[36:39]
    v_mfma_f32_16x16x32_bf16 v[40:43], v[100:103], v[152:155], v[40:43]
    v_mfma_f32_16x16x32_bf16 v[44:47], v[100:103], v[156:159], v[44:47]
    s_waitcnt lgkmcnt(4)
    v_mfma_f32_16x16x32_bf16 v[32:35], v[104:107], v[160:163], v[32:35]
    v_mfma_f32_16x16x32_bf16 v[36:39], v[104:107], v[164:167], v[36:39]
    v_mfma_f32_16x16x32_bf16 v[40:43], v[104:107], v[168:171], v[40:43]
    v_mfma_f32_16x16x32_bf16 v[44:47], v[104:107], v[172:175], v[44:47]
    s_waitcnt lgkmcnt(3)
    v_mfma_f32_16x16x32_bf16 v[32:35], v[108:111], v[176:179], v[32:35]
    v_mfma_f32_16x16x32_bf16 v[36:39], v[108:111], v[180:183], v[36:39]
    v_mfma_f32_16x16x32_bf16 v[40:43], v[108:111], v[184:187], v[40:43]
    v_mfma_f32_16x16x32_bf16 v[44:47], v[108:111], v[188:191], v[44:47]
    s_waitcnt lgkmcnt(2)
    v_mfma_f32_16x16x32_bf16 v[32:35], v[112:115], v[192:195], v[32:35]
    v_mfma_f32_16x16x32_bf16 v[36:39], v[112:115], v[196:199], v[36:39]
    v_mfma_f32_16x16x32_bf16 v[40:43], v[112:115], v[200:203], v[40:43]
    v_mfma_f32_16x16x32_bf16 v[44:47], v[112:115], v[204:207], v[44:47]
    s_waitcnt lgkmcnt(1)
    v_mfma_f32_16x16x32_bf16 v[32:35], v[116:119], v[208:211], v[32:35]
    v_mfma_f32_16x16x32_bf16 v[36:39], v[116:119], v[212:215], v[36:39]
    v_mfma_f32_16x16x32_bf16 v[40:43], v[116:119], v[216:219], v[40:43]
    v_mfma_f32_16x16x32_bf16 v[44:47], v[116:119], v[220:223], v[44:47]
    s_waitcnt lgkmcnt(0)
    v_mfma_f32_16x16x32_bf16 v[32:35], v[120:123], v[224:227], v[32:35]
    v_mfma_f32_16x16x32_bf16 v[36:39], v[120:123], v[228:231], v[36:39]
    v_mfma_f32_16x16x32_bf16 v[40:43], v[120:123], v[232:235], v[40:43]
    v_mfma_f32_16x16x32_bf16 v[44:47], v[120:123], v[236:239], v[44:47]
    s_nop 5
    v_cndmask_b32 v48, v32, v36, s[64:65]
    s_nop 0
    v_cndmask_b32 v49, v40, v44, s[64:65]
    v_cndmask_b32 v48, v48, v49, s[66:67]
    v_and_or_b32 v70, v48, -4, v23
    s_cmp_eq_u32 s70, 1
    s_cbranch_scc0 L_X01_pm
    buffer_store_dword v70, v22, s[36:39], s55 offen
    s_branch L_XB1
L_X01_pm:
    buffer_store_dword v70, v22, s[36:39], s55 offen sc1
    s_branch L_XB1
L_X23:
    v_lshlrev_b32 v4, 4, v0
    s_cmp_eq_u32 s3, 6
    s_cbranch_scc1 L_X2
    v_mov_b32 v60, 163360
    v_mov_b32 v61, 1
    s_waitcnt vmcnt(0) lgkmcnt(0)
    s_and_b32 s34, s34, 0xff
    s_mul_i32 s34, s34, 0x01010101
    s_xor_b32 s35, s34, 0x9e3779b9
    s_and_b32 s35, s35, 0x80808080
    s_and_b32 s34, s34, 0x7f7f7f7f
    s_add_u32 s34, s34, 0x1e377939
    s_xor_b32 s34, s34, s35
    s_mov_b64 exec, 1
    ds_add_u32 v60, v61 offset:12
    s_mov_b64 exec, -1
    s_lshl_b32 s52, s6, 3
    s_add_u32 s52, s52, s4
    s_lshl_b32 s52, s52, 24
    s_add_u32 s52, s52, 14680064
    s_mul_i32 s53, s7, 131200
    s_add_u32 s52, s52, s53
    v_mov_b32 v5, s52
    s_mul_i32 s52, s4, 458752
    s_lshl_b32 s53, s5, 7
    s_add_u32 s52, s52, s53
    v_mov_b32 v6, s52
    s_lshl_b32 s53, s2, 7
    v_mov_b32 v7, s53
    s_mov_b64 exec, 1
    global_load_dword v90, v5, s[12:13]
    global_load_dword v91, v6, s[16:17]
    global_load_dword v92, v7, s[20:21]
    global_load_dword v93, v7, s[22:23]
    global_load_dword v94, v7, s[24:25]
    s_mov_b64 exec, 0x1ff
    v_lshlrev_b32 v5, 12, v0
    s_lshl_b32 s52, s4, 15
    s_lshl_b32 s53, s6, 11
    s_lshl_b32 s54, s7, 7
    s_add_u32 s53, s53, s54
    s_add_u32 s52, s52, 229376
    v_add_u32 v5, s52, v5
    s_lshl_b32 s52, s4, 12
    s_add_u32 s52, s52, 106496
    v_writelane_b32 v5, s52, 8
    buffer_load_dword v95, v5, s[36:39], s53 offen sc1
    s_mov_b64 exec, -1
    s_branch L_XB1
L_X2:
    s_lshl_b32 s55, s6, 14
    s_lshl_b32 s56, s4, 11
    s_add_u32 s55, s55, s56
    s_add_u32 s55, s55, 147456
    s_add_u32 s56, s55, 32768
    v_lshlrev_b32 v5, 3, v0
    v_add_u32 v5, 160768, v5
    v_mov_b32 v60, 163360
    v_mov_b32 v61, 1
    s_waitcnt vmcnt(0) lgkmcnt(0)
    s_and_b32 s34, s34, 0xff
    s_mul_i32 s34, s34, 0x01010101
    s_xor_b32 s35, s34, 0x9e3779b9
    s_and_b32 s35, s35, 0x80808080
    s_and_b32 s34, s34, 0x7f7f7f7f
    s_add_u32 s34, s34, 0x1e377939
    s_xor_b32 s34, s34, s35
    s_mov_b64 exec, 1
    ds_add_u32 v60, v61 offset:12
    s_mov_b64 exec, -1
    v_and_b32 v36, 3, v0
    v_lshlrev_b32 v36, 3, v36
    v_lshrrev_b32 v36, v36, s34
    v_lshrrev_b32 v37, 2, v36
    v_lshrrev_b32 v38, 4, v36
    v_lshrrev_b32 v39, 6, v36
    s_mov_b32 s57, 0
L_q_wait:
    s_sleep 2
    ds_read_b32 v61, v60 offset:0
    s_waitcnt lgkmcnt(0)
    v_cmp_ne_u32 vcc, 1, v61
    s_cbranch_vccz L_q_go
    s_add_u32 s57, s57, 1
    s_cmp_lt_u32 s57, 65536
    s_cbranch_scc1 L_q_wait
L_q_go:
    s_mov_b32 s57, 0
L_X2_poll:
    buffer_load_dwordx4 v[44:47], v4, s[36:39], s55 offen sc1
    buffer_load_dwordx4 v[48:51], v4, s[36:39], s56 offen sc1
    buffer_load_dwordx4 v[52:55], v4, s[36:39], s55 offen offset:1024 sc1
    buffer_load_dwordx4 v[56:59], v4, s[36:39], s56 offen offset:1024 sc1
    s_waitcnt vmcnt(3)
    v_xor_b32 v40, v44, v36
    v_bitop3_b32 v40, v40, v45, v37 bitop3:0xf6
    v_bitop3_b32 v40, v40, v46, v38 bitop3:0xf6
    v_bitop3_b32 v40, v40, v47, v39 bitop3:0xf6
    s_waitcnt vmcnt(2)
    v_bitop3_b32 v40, v40, v48, v36 bitop3:0xf6
    v_bitop3_b32 v40, v40, v49, v37 bitop3:0xf6
    v_bitop3_b32 v40, v40, v50, v38 bitop3:0xf6
    v_bitop3_b32 v40, v40, v51, v39 bitop3:0xf6
    s_waitcnt vmcnt(1)
    v_bitop3_b32 v40, v40, v52, v36 bitop3:0xf6
    v_bitop3_b32 v40, v40, v53, v37 bitop3:0xf6
    v_bitop3_b32 v40, v40, v54, v38 bitop3:0xf6
    v_bitop3_b32 v40, v40, v55, v39 bitop3:0xf6
    s_waitcnt vmcnt(0)
    v_bitop3_b32 v40, v40, v56, v36 bitop3:0xf6
    v_bitop3_b32 v40, v40, v57, v37 bitop3:0xf6
    v_bitop3_b32 v40, v40, v58, v38 bitop3:0xf6
    v_bitop3_b32 v40, v40, v59, v39 bitop3:0xf6
    v_and_b32 v40, 3, v40
    v_cmp_ne_u32 vcc, 0, v40
    s_cbranch_vccz L_X2_got
    s_add_u32 s57, s57, 1
    s_and_b32 s35, s57, 127
    s_cbranch_scc1 L_nf_30
    buffer_wbl2 sc1
    s_waitcnt vmcnt(0)
L_nf_30:
    s_cmp_lt_u32 s57, 65536
    s_cbranch_scc1 L_X2_poll
L_X2_got:
    v_and_b32 v44, -4, v44
    v_and_b32 v45, -4, v45
    v_and_b32 v46, -4, v46
    v_and_b32 v47, -4, v47
    v_and_b32 v48, -4, v48
    v_and_b32 v49, -4, v49
    v_and_b32 v50, -4, v50
    v_and_b32 v51, -4, v51
    v_and_b32 v52, -4, v52
    v_and_b32 v53, -4, v53
    v_and_b32 v54, -4, v54
    v_and_b32 v55, -4, v55
    v_and_b32 v56, -4, v56
    v_and_b32 v57, -4, v57
    v_and_b32 v58, -4, v58
    v_and_b32 v59, -4, v59
    v_pk_add_f32 v[44:45], v[44:45], v[48:49]
    v_pk_add_f32 v[46:47], v[46:47], v[50:51]
    v_pk_add_f32 v[48:49], v[52:53], v[56:57]
    v_pk_add_f32 v[50:51], v[54:55], v[58:59]
    v_cvt_pk_bf16_f32 v52, v44, v45
    v_cvt_pk_bf16_f32 v53, v46, v47
    v_cvt_pk_bf16_f32 v54, v48, v49
    v_cvt_pk_bf16_f32 v55, v50, v51
    ds_write_b64 v5, v[52:53]
    ds_write_b64 v5, v[54:55] offset:512
    s_waitcnt lgkmcnt(0)
L_XB1:
    v_mov_b32 v84, 0
    v_mov_b32 v88, 0
    v_mov_b32 v96, 0
    v_mov_b32 v97, 0
    v_mov_b32 v106, 0
    s_sub_u32 s52, s5, 14
    s_cmp_lt_u32 s52, 14
    s_cbranch_scc0 L_PV
    s_mov_b32 s40, s8
    s_mov_b32 s41, s9
    s_mov_b32 s42, 1792
    s_mov_b32 s43, 0x20000
    s_mov_b32 s64, 0xfffffff
    s_mov_b32 s65, 0xfffffff
    v_and_b32 v4, 31, v0
    v_lshrrev_b32 v5, 5, v0
    v_lshl_add_u32 v6, v4, 1, v5
    v_mov_b32 v7, 0x1000000
    v_lshlrev_b32 v8, 2, v6
    v_cndmask_b32 v8, v7, v8, s[64:65]
    v_lshlrev_b32 v9, 3, v6
    v_cndmask_b32 v10, v7, v9, s[64:65]
    v_mul_u32_u24 v84, 28672, v5
    v_lshrrev_b32 v13, 2, v4
    v_lshl_add_u32 v84, v13, 7, v84
    v_and_b32 v13, 3, v4
    v_lshl_add_u32 v84, v13, 4, v84
    v_cndmask_b32 v84, v7, v84, s[64:65]
    s_mul_i32 s59, s71, 448
    s_mul_i32 s53, s6, 10752
    s_add_u32 s53, s53, s59
    s_add_u32 s53, s53, 7680
    s_add_u32 s54, s53, 21504
    v_and_b32 v36, 7, v6
    v_lshlrev_b32 v36, 2, v36
    v_lshrrev_b32 v36, v36, s34
    v_lshrrev_b32 v37, 2, v36
    v_and_b32 v85, 0x7c, v4
    v_lshlrev_b32 v85, 3, v85
    v_bfe_u32 v62, v4, 1, 1
    v_lshl_add_u32 v85, v62, 3, v85
    v_and_b32 v62, 1, v4
    v_lshl_add_u32 v85, v62, 4, v85
    v_and_b32 v87, 3, v4
    v_lshlrev_b32 v87, 3, v87
    v_lshrrev_b32 v87, v87, s34
    v_and_b32 v87, 0xff, v87
    v_cndmask_b32 v87, 0, v87, s[64:65]
    v_lshl_add_u32 v85, v5, 2, v85
    s_mul_i32 s60, s71, 224
    s_add_u32 s60, s60, 135168
    s_lshl_b32 s61, s71, 5
    s_add_u32 s61, s61, 135840
    v_mov_b32 v13, s60
    v_mov_b32 v14, s61
    v_cndmask_b32 v13, v14, v13, s[64:65]
    v_add_u32 v85, v85, v13
    s_add_u32 s60, s59, 139520
    s_lshl_b32 s61, s71, 6
    s_add_u32 s61, s61, 140864
    v_mov_b32 v13, s60
    v_mov_b32 v14, s61
    v_cndmask_b32 v13, v14, v13, s[64:65]
    v_add_u32 v86, v9, v13
    s_mov_b32 s57, 0
L_r_wait:
    s_sleep 2
    ds_read_b32 v61, v60 offset:0
    s_waitcnt lgkmcnt(0)
    v_cmp_ne_u32 vcc, 1, v61
    s_cbranch_vccz L_r_go
    s_add_u32 s57, s57, 1
    s_cmp_lt_u32 s57, 65536
    s_cbranch_scc1 L_r_wait
L_r_go:
    s_mul_i32 s52, s6, 896
    s_mul_i32 s55, s71, 224
    s_add_u32 s55, s55, s52
    buffer_load_dword v76, v8, s[40:43], s55 offen
    buffer_load_ushort v71, off, s[40:43], s52
    s_mov_b32 s100, s53
    s_mov_b32 s101, s54
    v_mov_b32 v88, v10
    v_mov_b32 v89, v36
    buffer_load_dwordx2 v[96:97], v88, s[36:39], s100 offen offset:0 sc1
    buffer_load_dwordx2 v[98:99], v88, s[36:39], s100 offen offset:1792 sc1
    buffer_load_dwordx2 v[100:101], v88, s[36:39], s100 offen offset:3584 sc1
    buffer_load_dwordx2 v[102:103], v88, s[36:39], s101 offen offset:0 sc1
    buffer_load_dwordx2 v[104:105], v88, s[36:39], s101 offen offset:1792 sc1
    buffer_load_dwordx2 v[106:107], v88, s[36:39], s101 offen offset:3584 sc1
L_PV:
    s_setprio 0
    v_bfe_u32 v12, v2, 2, 1
    v_mul_u32_u24 v13, 528, v12
    v_lshl_add_u32 v13, v1, 4, v13
    v_add_u32 v13, 161792, v13
    v_and_b32 v12, 1, v2
    v_and_b32 v4, 1, v1
    v_lshlrev_b32 v14, 14, v4
    v_lshrrev_b32 v5, 2, v2
    v_lshl_add_u32 v4, v4, 2, v5
    v_lshrrev_b32 v5, 1, v1
    v_lshl_add_u32 v14, v5, 6, v14
    v_lshl_add_u32 v14, v2, 2, v14
    v_lshlrev_b32 v5, 13, v5
    v_lshl_add_u32 v5, v4, 9, v5
    v_lshl_add_u32 v5, v12, 3, v5
    v_bfe_u32 v6, v2, 1, 1
    s_lshl_b32 s63, s71, 3
    v_add_u32 v6, s63, v6
    v_lshlrev_b32 v4, 1, v4
    v_xor_b32 v6, v6, v4
    v_lshl_add_u32 v8, v6, 4, v5
    v_xor_b32 v9, 32, v8
    v_xor_b32 v10, 64, v8
    v_xor_b32 v11, 96, v8
    s_lshl_b32 s58, s4, 15
    s_lshl_b32 s59, s71, 12
    s_add_u32 s58, s58, s59
    s_lshl_b32 s59, s6, 11
    s_add_u32 s58, s58, s59
    s_lshl_b32 s59, s7, 7
    s_add_u32 s58, s58, s59
    s_add_u32 s58, s58, 229376
    v_lshrrev_b32 v15, 1, v1
    v_lshl_add_u32 v15, v15, 4, v2
    v_lshrrev_b32 v15, v15, s34
    v_and_b32 v15, 1, v15
    s_mov_b32 s66, 0x0
    s_mov_b32 s67, 0xffffffff
    s_cmp_lt_u32 s5, 14
    s_cbranch_scc0 L_PV_b1
    s_lshl_b32 s63, s6, 2
    s_xor_b32 s63, s63, s3
    s_lshl_b32 s52, s4, 3
    s_add_u32 s52, s52, s63
    s_lshl_b32 s54, s52, 12
    s_add_u32 s54, s54, 229376
    s_mul_i32 s52, s52, 57344
    s_lshl_b32 s59, s5, 6
    s_add_u32 s52, s52, s59
    s_lshl_b32 s56, s3, 12
    s_add_u32 s60, s56, 32768
    v_bfe_u32 v106, v0, 2, 1
    v_lshlrev_b32 v106, 4, v106
    v_and_b32 v102, 1, v1
    v_lshl_add_u32 v106, v102, 2, v106
    v_lshrrev_b32 v103, 5, v0
    v_lshl_add_u32 v106, v103, 1, v106
    v_bfe_u32 v103, v0, 3, 1
    v_add_u32 v106, v106, v103
    v_mul_u32_u24 v106, 896, v106
    v_and_b32 v103, 3, v0
    v_lshlrev_b32 v102, 1, v102
    v_xor_b32 v103, v103, v102
    v_lshl_add_u32 v106, v103, 4, v106
    v_and_b32 v96, 7, v0
    v_xor_b32 v96, v96, v1
    v_lshlrev_b32 v96, 4, v96
    v_lshrrev_b32 v97, 3, v0
    v_lshl_add_u32 v96, v97, 7, v96
    v_xor_b32 v97, 64, v96
    v_lshrrev_b32 v98, 1, v2
    v_xor_b32 v98, v98, v1
    v_lshlrev_b32 v98, 4, v98
    v_lshl_add_u32 v98, v2, 7, v98
    v_add_u32 v98, s60, v98
    v_xor_b32 v99, 64, v98
    s_lshr_b32 s63, s63, 2
    s_lshl_b32 s59, s63, 7
    s_add_u32 s59, s59, 163104
    v_lshl_add_u32 v100, v1, 4, s59
    s_lshl_b32 s59, s63, 10
    s_lshl_b32 s63, s71, 2
    s_add_u32 s59, s59, s63
    s_add_u32 s59, s59, 131072
    v_lshl_add_u32 v101, v0, 4, s59
    v_lshlrev_b32 v102, 2, v1
    v_lshrrev_b32 v102, v102, s34
    v_lshrrev_b32 v104, 1, v1
    v_lshlrev_b32 v104, 10, v104
    v_and_b32 v103, 1, v1
    v_mul_u32_u24 v103, 288, v103
    v_add_u32 v104, v104, v103
    v_lshrrev_b32 v103, 2, v2
    v_lshl_add_u32 v104, v103, 6, v104
    v_and_b32 v103, 3, v2
    v_lshl_add_u32 v104, v103, 3, v104
    v_add_u32 v104, s56, v104
    v_xor_b32 v105, 32, v104
    v_bfe_u32 v108, v102, 0, 1
    v_bfe_u32 v109, v102, 1, 1
    v_bfe_u32 v110, v102, 2, 1
    v_bfe_u32 v111, v102, 3, 1
    v_bfe_u32 v112, v102, 16, 1
    v_bfe_u32 v113, v102, 17, 1
    v_bfe_u32 v114, v102, 18, 1
    v_bfe_u32 v115, v102, 19, 1
    v_sub_co_u32 v108, vcc, 0, v108
    s_nop 1
    v_subb_co_u32 v109, vcc, 0, v109, vcc
    v_sub_co_u32 v110, vcc, 0, v110
    s_nop 1
    v_subb_co_u32 v111, vcc, 0, v111, vcc
    v_sub_co_u32 v112, vcc, 0, v112
    s_nop 1
    v_subb_co_u32 v113, vcc, 0, v113, vcc
    v_sub_co_u32 v114, vcc, 0, v114
    s_nop 1
    v_subb_co_u32 v115, vcc, 0, v115, vcc
L_PV_b1:
    s_barrier
    ds_read_b64_tr_b16 v[128:129], v8 offset:0
    ds_read_b64_tr_b16 v[130:131], v8 offset:4096
    ds_read_b64_tr_b16 v[132:133], v9 offset:0
    ds_read_b64_tr_b16 v[134:135], v9 offset:4096
    ds_read_b64_tr_b16 v[136:137], v10 offset:0
    ds_read_b64_tr_b16 v[138:139], v10 offset:4096
    ds_read_b64_tr_b16 v[140:141], v11 offset:0
    ds_read_b64_tr_b16 v[142:143], v11 offset:4096
    s_waitcnt lgkmcnt(7)
    ds_read_b64_tr_b16 v[144:145], v8 offset:16384
    ds_read_b64_tr_b16 v[146:147], v8 offset:20480
    ds_read_b64_tr_b16 v[148:149], v9 offset:16384
    ds_read_b64_tr_b16 v[150:151], v9 offset:20480
    ds_read_b64_tr_b16 v[152:153], v10 offset:16384
    ds_read_b64_tr_b16 v[154:155], v10 offset:20480
    ds_read_b64_tr_b16 v[156:157], v11 offset:16384
    ds_read_b64_tr_b16 v[158:159], v11 offset:20480
    s_waitcnt lgkmcnt(0)
    s_barrier
    s_barrier
    ds_read_b128 v[16:19], v13 offset:0
    ds_read_b128 v[20:23], v13 offset:64
    ds_read_b128 v[24:27], v13 offset:128
    ds_read_b128 v[28:31], v13 offset:192
    ds_read_b64_tr_b16 v[160:161], v8 offset:32768
    ds_read_b64_tr_b16 v[162:163], v8 offset:36864
    ds_read_b64_tr_b16 v[164:165], v9 offset:32768
    ds_read_b64_tr_b16 v[166:167], v9 offset:36864
    ds_read_b64_tr_b16 v[168:169], v10 offset:32768
    ds_read_b64_tr_b16 v[170:171], v10 offset:36864
    ds_read_b64_tr_b16 v[172:173], v11 offset:32768
    ds_read_b64_tr_b16 v[174:175], v11 offset:36864
    s_waitcnt lgkmcnt(11)
    v_mfma_f32_16x16x32_bf16 v[48:51], v[16:19], v[128:131], 0
    v_mfma_f32_16x16x32_bf16 v[52:55], v[16:19], v[132:135], 0
    v_mfma_f32_16x16x32_bf16 v[56:59], v[16:19], v[136:139], 0
    v_mfma_f32_16x16x32_bf16 v[60:63], v[16:19], v[140:143], 0
    s_waitcnt lgkmcnt(10)
    v_mfma_f32_16x16x32_bf16 v[48:51], v[20:23], v[144:147], v[48:51]
    v_mfma_f32_16x16x32_bf16 v[52:55], v[20:23], v[148:151], v[52:55]
    v_mfma_f32_16x16x32_bf16 v[56:59], v[20:23], v[152:155], v[56:59]
    v_mfma_f32_16x16x32_bf16 v[60:63], v[20:23], v[156:159], v[60:63]
    ds_read_b128 v[32:35], v13 offset:256
    ds_read_b128 v[36:39], v13 offset:320
    ds_read_b128 v[40:43], v13 offset:384
    ds_read_b128 v[44:47], v13 offset:448
    s_waitcnt lgkmcnt(7)
    ds_read_b64_tr_b16 v[176:177], v8 offset:49152
    ds_read_b64_tr_b16 v[178:179], v8 offset:53248
    ds_read_b64_tr_b16 v[180:181], v9 offset:49152
    ds_read_b64_tr_b16 v[182:183], v9 offset:53248
    ds_read_b64_tr_b16 v[184:185], v10 offset:49152
    ds_read_b64_tr_b16 v[186:187], v10 offset:53248
    ds_read_b64_tr_b16 v[188:189], v11 offset:49152
    ds_read_b64_tr_b16 v[190:191], v11 offset:53248
    s_waitcnt lgkmcnt(8)
    v_mfma_f32_16x16x32_bf16 v[48:51], v[24:27], v[160:163], v[48:51]
    v_mfma_f32_16x16x32_bf16 v[52:55], v[24:27], v[164:167], v[52:55]
    v_mfma_f32_16x16x32_bf16 v[56:59], v[24:27], v[168:171], v[56:59]
    v_mfma_f32_16x16x32_bf16 v[60:63], v[24:27], v[172:175], v[60:63]
    s_waitcnt lgkmcnt(0)
    v_mfma_f32_16x16x32_bf16 v[48:51], v[28:31], v[176:179], v[48:51]
    v_mfma_f32_16x16x32_bf16 v[52:55], v[28:31], v[180:183], v[52:55]
    v_mfma_f32_16x16x32_bf16 v[56:59], v[28:31], v[184:187], v[56:59]
    v_mfma_f32_16x16x32_bf16 v[60:63], v[28:31], v[188:191], v[60:63]
    v_add_u32 v8, 0x10000, v8
    v_add_u32 v9, 0x10000, v9
    v_add_u32 v10, 0x10000, v10
    v_add_u32 v11, 0x10000, v11
    s_sub_u32 s35, s5, 14
    s_cmp_lt_u32 s35, 14
    s_cbranch_scc0 L_mr_end
    s_mov_b32 s64, 0xfffffff
    s_mov_b32 s65, 0xfffffff
    v_lshrrev_b32 v111, 2, v89
    v_mov_b32 v110, v89
    s_mov_b32 s57, 0
    s_branch L_LN_chkm
L_LN_pollm:
    buffer_load_dwordx2 v[96:97], v88, s[36:39], s100 offen offset:0 sc1
    buffer_load_dwordx2 v[98:99], v88, s[36:39], s100 offen offset:1792 sc1
    buffer_load_dwordx2 v[100:101], v88, s[36:39], s100 offen offset:3584 sc1
    buffer_load_dwordx2 v[102:103], v88, s[36:39], s101 offen offset:0 sc1
    buffer_load_dwordx2 v[104:105], v88, s[36:39], s101 offen offset:1792 sc1
    buffer_load_dwordx2 v[106:107], v88, s[36:39], s101 offen offset:3584 sc1
L_LN_chkm:
    s_waitcnt vmcnt(0)
    v_xor_b32 v108, v96, v110
    v_bitop3_b32 v108, v108, v97, v111 bitop3:0xf6
    v_bitop3_b32 v108, v108, v98, v110 bitop3:0xf6
    v_bitop3_b32 v108, v108, v99, v111 bitop3:0xf6
    v_bitop3_b32 v108, v108, v100, v110 bitop3:0xf6
    v_bitop3_b32 v108, v108, v101, v111 bitop3:0xf6
    v_bitop3_b32 v108, v108, v102, v110 bitop3:0xf6
    v_bitop3_b32 v108, v108, v103, v111 bitop3:0xf6
    v_bitop3_b32 v108, v108, v104, v110 bitop3:0xf6
    v_bitop3_b32 v108, v108, v105, v111 bitop3:0xf6
    v_bitop3_b32 v108, v108, v106, v110 bitop3:0xf6
    v_bitop3_b32 v108, v108, v107, v111 bitop3:0xf6
    v_and_b32 v108, 3, v108
    v_cmp_ne_u32 vcc, 0, v108
    s_and_b64 vcc, vcc, s[64:65]
    s_cbranch_vccz L_LN_gotm
    s_add_u32 s57, s57, 1
    s_and_b32 s35, s57, 127
    s_cbranch_scc1 L_nf_31
    buffer_wbl2 sc1
    s_waitcnt vmcnt(0)
L_nf_31:
    s_cmp_lt_u32 s57, 65536
    s_cbranch_scc1 L_LN_pollm
L_LN_gotm:
    v_and_b32 v96, -4, v96
    v_and_b32 v97, -4, v97
    v_and_b32 v98, -4, v98
    v_and_b32 v99, -4, v99
    v_and_b32 v100, -4, v100
    v_and_b32 v101, -4, v101
    v_and_b32 v102, -4, v102
    v_and_b32 v103, -4, v103
    v_and_b32 v104, -4, v104
    v_and_b32 v105, -4, v105
    v_and_b32 v106, -4, v106
    v_and_b32 v107, -4, v107
    v_pk_add_f32 v[78:79], v[96:97], v[102:103]
    v_pk_add_f32 v[98:99], v[98:99], v[104:105]
    v_pk_add_f32 v[80:81], v[100:101], v[106:107]
    v_cvt_pk_bf16_f32 v83, v98, v99
    v_cvt_pk_bf16_f32 v96, v78, v79
    v_cvt_pk_bf16_f32 v97, v80, v81
    v_lshlrev_b32 v78, 16, v96
    v_and_b32 v79, 0xffff0000, v96
    v_lshlrev_b32 v80, 16, v97
    v_and_b32 v81, 0xffff0000, v97
    v_add_f32 v80, 1.0, v80
    v_add_f32 v81, 1.0, v81
    v_cvt_pk_bf16_f32 v82, v80, v81
    v_lshlrev_b32 v80, 16, v82
    v_and_b32 v81, 0xffff0000, v82
    v_and_b32 v77, 0xffff0000, v76
    v_lshlrev_b32 v76, 16, v76
    v_lshlrev_b32 v71, 16, v71
    v_cndmask_b32 v71, 0, v71, s[64:65]
    v_sub_f32 v76, v76, v71
    v_sub_f32 v77, v77, v71
    ds_write_b32 v85, v82 offset:2080
    ds_write_b32 v85, v83 offset:3120
    s_waitcnt lgkmcnt(0)
L_mr_end:
    s_barrier
    ds_read_b64_tr_b16 v[192:193], v8 offset:0
    ds_read_b64_tr_b16 v[194:195], v8 offset:4096
    ds_read_b64_tr_b16 v[196:197], v9 offset:0
    ds_read_b64_tr_b16 v[198:199], v9 offset:4096
    ds_read_b64_tr_b16 v[200:201], v10 offset:0
    ds_read_b64_tr_b16 v[202:203], v10 offset:4096
    ds_read_b64_tr_b16 v[204:205], v11 offset:0
    ds_read_b64_tr_b16 v[206:207], v11 offset:4096
    s_waitcnt lgkmcnt(7)
    ds_read_b64_tr_b16 v[208:209], v8 offset:16384
    ds_read_b64_tr_b16 v[210:211], v8 offset:20480
    ds_read_b64_tr_b16 v[212:213], v9 offset:16384
    ds_read_b64_tr_b16 v[214:215], v9 offset:20480
    ds_read_b64_tr_b16 v[216:217], v10 offset:16384
    ds_read_b64_tr_b16 v[218:219], v10 offset:20480
    ds_read_b64_tr_b16 v[220:221], v11 offset:16384
    ds_read_b64_tr_b16 v[222:223], v11 offset:20480
    s_waitcnt lgkmcnt(8)
    v_mfma_f32_16x16x32_bf16 v[48:51], v[32:35], v[192:195], v[48:51]
    v_mfma_f32_16x16x32_bf16 v[52:55], v[32:35], v[196:199], v[52:55]
    v_mfma_f32_16x16x32_bf16 v[56:59], v[32:35], v[200:203], v[56:59]
    v_mfma_f32_16x16x32_bf16 v[60:63], v[32:35], v[204:207], v[60:63]
    s_waitcnt lgkmcnt(0)
    v_mfma_f32_16x16x32_bf16 v[48:51], v[36:39], v[208:211], v[48:51]
    v_mfma_f32_16x16x32_bf16 v[52:55], v[36:39], v[212:215], v[52:55]
    v_mfma_f32_16x16x32_bf16 v[56:59], v[36:39], v[216:219], v[56:59]
    v_mfma_f32_16x16x32_bf16 v[60:63], v[36:39], v[220:223], v[60:63]
    s_barrier
    ds_read_b64_tr_b16 v[224:225], v8 offset:32768
    ds_read_b64_tr_b16 v[226:227], v8 offset:36864
    ds_read_b64_tr_b16 v[228:229], v9 offset:32768
    ds_read_b64_tr_b16 v[230:231], v9 offset:36864
    ds_read_b64_tr_b16 v[232:233], v10 offset:32768
    ds_read_b64_tr_b16 v[234:235], v10 offset:36864
    ds_read_b64_tr_b16 v[236:237], v11 offset:32768
    ds_read_b64_tr_b16 v[238:239], v11 offset:36864
    s_waitcnt lgkmcnt(6)
    v_mfma_f32_16x16x32_bf16 v[48:51], v[40:43], v[224:227], v[48:51]
    s_waitcnt lgkmcnt(4)
    v_mfma_f32_16x16x32_bf16 v[52:55], v[40:43], v[228:231], v[52:55]
    s_waitcnt lgkmcnt(2)
    v_mfma_f32_16x16x32_bf16 v[56:59], v[40:43], v[232:235], v[56:59]
    s_waitcnt lgkmcnt(0)
    v_mfma_f32_16x16x32_bf16 v[60:63], v[40:43], v[236:239], v[60:63]
    s_barrier
    ds_read_b64_tr_b16 v[240:241], v8 offset:49152
    ds_read_b64_tr_b16 v[242:243], v8 offset:53248
    ds_read_b64_tr_b16 v[244:245], v9 offset:49152
    ds_read_b64_tr_b16 v[246:247], v9 offset:53248
    ds_read_b64_tr_b16 v[248:249], v10 offset:49152
    ds_read_b64_tr_b16 v[250:251], v10 offset:53248
    ds_read_b64_tr_b16 v[252:253], v11 offset:49152
    ds_read_b64_tr_b16 v[254:255], v11 offset:53248
    s_waitcnt lgkmcnt(6)
    v_mfma_f32_16x16x32_bf16 v[48:51], v[44:47], v[240:243], v[48:51]
    s_waitcnt lgkmcnt(4)
    v_mfma_f32_16x16x32_bf16 v[52:55], v[44:47], v[244:247], v[52:55]
    s_waitcnt lgkmcnt(2)
    v_mfma_f32_16x16x32_bf16 v[56:59], v[44:47], v[248:251], v[56:59]
    s_waitcnt lgkmcnt(0)
    v_mfma_f32_16x16x32_bf16 v[60:63], v[44:47], v[252:255], v[60:63]
    s_nop 3
    v_cvt_pk_bf16_f32 v68, v48, v52
    s_nop 2
    v_cvt_pk_bf16_f32 v69, v56, v60
    v_cndmask_b32 v68, v68, v69, s[66:67]
    v_and_or_b32 v68, v68, -2, v15
    buffer_store_dword v68, v14, s[36:39], s58 offen
    s_barrier
    s_setprio 1
    s_cmp_lt_u32 s5, 14
    s_cbranch_scc0 L_notwo
    s_setprio 1
    s_mov_b32 s40, s16
    s_mov_b32 s41, s17
    s_mov_b32 s42, 3670016
    s_mov_b32 s43, 0x20000
    s_add_u32 m0, s56, 0
    s_nop 0
    buffer_load_dwordx4 v106, s[40:43], s52 offen  lds
    s_add_u32 m0, s56, 1024
    s_add_u32 s52, s52, 7168
    buffer_load_dwordx4 v106, s[40:43], s52 offen  lds
    s_add_u32 m0, s56, 2048
    s_add_u32 s52, s52, 21504
    buffer_load_dwordx4 v106, s[40:43], s52 offen  lds
    s_add_u32 m0, s56, 3072
    s_add_u32 s52, s52, 7168
    buffer_load_dwordx4 v106, s[40:43], s52 offen  lds
    s_setprio 0
    s_branch L_WO_a
L_WX:
    s_mov_b32 s40, s16
    s_mov_b32 s41, s17
    s_mov_b32 s42, 3670016
    s_mov_b32 s43, 0x20000
    s_lshl_b32 s63, s6, 2
    s_xor_b32 s63, s63, s3
    s_lshl_b32 s52, s4, 3
    s_add_u32 s52, s52, s63
    s_lshl_b32 s54, s52, 12
    s_add_u32 s54, s54, 229376
    s_mul_i32 s52, s52, 57344
    s_lshl_b32 s59, s5, 6
    s_add_u32 s52, s52, s59
    s_lshl_b32 s56, s3, 12
    s_add_u32 s60, s56, 32768
    v_bfe_u32 v106, v0, 2, 1
    v_lshlrev_b32 v106, 4, v106
    v_and_b32 v102, 1, v1
    v_lshl_add_u32 v106, v102, 2, v106
    v_lshrrev_b32 v103, 5, v0
    v_lshl_add_u32 v106, v103, 1, v106
    v_bfe_u32 v103, v0, 3, 1
    v_add_u32 v106, v106, v103
    v_mul_u32_u24 v106, 896, v106
    v_and_b32 v103, 3, v0
    v_lshlrev_b32 v102, 1, v102
    v_xor_b32 v103, v103, v102
    v_lshl_add_u32 v106, v103, 4, v106
    v_and_b32 v96, 7, v0
    v_xor_b32 v96, v96, v1
    v_lshlrev_b32 v96, 4, v96
    v_lshrrev_b32 v97, 3, v0
    v_lshl_add_u32 v96, v97, 7, v96
    v_xor_b32 v97, 64, v96
    v_lshrrev_b32 v98, 1, v2
    v_xor_b32 v98, v98, v1
    v_lshlrev_b32 v98, 4, v98
    v_lshl_add_u32 v98, v2, 7, v98
    v_add_u32 v98, s60, v98
    v_xor_b32 v99, 64, v98
    s_lshr_b32 s63, s63, 2
    s_lshl_b32 s59, s63, 7
    s_add_u32 s59, s59, 163104
    v_lshl_add_u32 v100, v1, 4, s59
    s_lshl_b32 s59, s63, 10
    s_lshl_b32 s63, s71, 2
    s_add_u32 s59, s59, s63
    s_add_u32 s59, s59, 131072
    v_lshl_add_u32 v101, v0, 4, s59
    v_lshlrev_b32 v102, 2, v1
    v_lshrrev_b32 v102, v102, s34
    v_lshrrev_b32 v104, 1, v1
    v_lshlrev_b32 v104, 10, v104
    v_and_b32 v103, 1, v1
    v_mul_u32_u24 v103, 288, v103
    v_add_u32 v104, v104, v103
    v_lshrrev_b32 v103, 2, v2
    v_lshl_add_u32 v104, v103, 6, v104
    v_and_b32 v103, 3, v2
    v_lshl_add_u32 v104, v103, 3, v104
    v_add_u32 v104, s56, v104
    v_xor_b32 v105, 32, v104
    v_bfe_u32 v108, v102, 0, 1
    v_bfe_u32 v109, v102, 1, 1
    v_bfe_u32 v110, v102, 2, 1
    v_bfe_u32 v111, v102, 3, 1
    v_bfe_u32 v112, v102, 16, 1
    v_bfe_u32 v113, v102, 17, 1
    v_bfe_u32 v114, v102, 18, 1
    v_bfe_u32 v115, v102, 19, 1
    v_sub_co_u32 v108, vcc, 0, v108
    s_nop 1
    v_subb_co_u32 v109, vcc, 0, v109, vcc
    v_sub_co_u32 v110, vcc, 0, v110
    s_nop 1
    v_subb_co_u32 v111, vcc, 0, v111, vcc
    v_sub_co_u32 v112, vcc, 0, v112
    s_nop 1
    v_subb_co_u32 v113, vcc, 0, v113, vcc
    v_sub_co_u32 v114, vcc, 0, v114
    s_nop 1
    v_subb_co_u32 v115, vcc, 0, v115, vcc
    v_and_b32 v4, 31, v0
    v_lshlrev_b32 v4, 7, v4
    v_lshrrev_b32 v5, 5, v0
    v_lshl_add_u32 v4, v5, 4, v4
    s_lshl_b32 s55, s4, 12
    s_add_u32 s55, s55, 106496
    v_lshlrev_b32 v6, 2, v0
    v_add_u32 v6, 163104, v6
    v_lshlrev_b32 v8, 4, v0
    v_add_u32 v8, 131072, v8
    v_lshrrev_b32 v10, 5, v0
    v_mul_u32_u24 v10, 3584, v10
    v_lshl_add_u32 v10, v2, 2, v10
    v_and_b32 v12, 1, v1
    v_lshl_add_u32 v10, v12, 7, v10
    s_mul_i32 s58, s4, 7168
    s_lshl_b32 s59, s5, 8
    s_add_u32 s58, s58, s59
    s_add_u32 s58, s58, 720896
    s_lshl_b32 s59, s3, 15
    s_add_u32 s58, s58, s59
    s_add_u32 s62, s58, 131072
    v_lshrrev_b32 v30, 2, v0
    v_and_b32 v31, 3, v0
    v_cmp_eq_u32 vcc, 0, v31
    v_mov_b32 v31, 0xffffff00
    s_nop 0
    v_cndmask_b32 v31, -1, v31, vcc
    v_and_b32 v30, 3, v30
    v_lshlrev_b32 v30, 3, v30
    v_lshrrev_b32 v30, v30, s34
    v_and_b32 v30, 0xff, v30
    v_cndmask_b32 v30, 0, v30, vcc
    s_waitcnt vmcnt(4)
    s_barrier
    s_cmp_eq_u32 s3, 3
    s_cbranch_scc0 L_WO_ns
    buffer_load_dwordx4 v[72:75], v4, s[36:39], s55 offen sc1
L_WO_ns:
    s_add_u32 m0, s56, 0
    s_nop 0
    buffer_load_dwordx4 v106, s[40:43], s52 offen  lds
    s_add_u32 m0, s56, 1024
    s_add_u32 s52, s52, 7168
    buffer_load_dwordx4 v106, s[40:43], s52 offen  lds
    s_add_u32 m0, s56, 2048
    s_add_u32 s52, s52, 21504
    buffer_load_dwordx4 v106, s[40:43], s52 offen  lds
    s_waitcnt vmcnt(3)
    s_barrier
    s_barrier
    s_add_u32 m0, s56, 3072
    s_add_u32 s52, s52, 7168
    buffer_load_dwordx4 v106, s[40:43], s52 offen  lds
L_WO_a:
    s_mov_b32 m0, s60
    s_nop 0
    buffer_load_dwordx4 v96, s[36:39], s54 offen offset:0 sc1 lds
    buffer_load_dwordx4 v97, s[36:39], s54 offen offset:1024 sc1 lds
    buffer_load_dwordx4 v96, s[36:39], s54 offen offset:2048 sc1 lds
    buffer_load_dwordx4 v97, s[36:39], s54 offen offset:3072 sc1 lds
    s_mov_b32 s57, 0
    s_cmp_eq_u32 s3, 3
    s_cbranch_scc0 L_WO_nw
    s_mov_b32 s63, 0x3db8aa3b
    s_waitcnt vmcnt(8)
    s_branch L_WO_chkst
L_WO_pollst:
    buffer_load_dwordx4 v[72:75], v4, s[36:39], s55 offen sc1
    s_waitcnt vmcnt(0)
L_WO_chkst:
    v_xor_b32 v20, s34, v73
    v_xor_b32 v21, s34, v75
    v_or_b32 v20, v20, v21
    v_cmp_ne_u32 vcc, 0, v20
    s_cbranch_vccz L_WO_gotst
    s_add_u32 s57, s57, 1
    s_and_b32 s35, s57, 127
    s_cbranch_scc1 L_nf_32
    buffer_wbl2 sc1
    s_waitcnt vmcnt(0)
L_nf_32:
    s_cmp_lt_u32 s57, 65536
    s_cbranch_scc1 L_WO_pollst
L_WO_gotst:
    v_mov_b32 v20, v72
    s_nop 1
    v_max_f32_dpp v20, v20, v20 row_ror:1 row_mask:0xf bank_mask:0xf
    s_nop 1
    v_max_f32_dpp v20, v20, v20 row_ror:2 row_mask:0xf bank_mask:0xf
    s_nop 1
    v_max_f32_dpp v20, v20, v20 row_ror:4 row_mask:0xf bank_mask:0xf
    s_nop 1
    v_max_f32_dpp v20, v20, v20 row_ror:8 row_mask:0xf bank_mask:0xf
    v_sub_f32 v16, v72, v20
    v_mul_f32 v16, s63, v16
    v_exp_f32 v16, v16
    s_nop 0
    v_mul_f32 v18, v16, v74
    s_nop 1
    v_add_f32_dpp v18, v18, v18 row_ror:1 row_mask:0xf bank_mask:0xf
    s_nop 1
    v_add_f32_dpp v18, v18, v18 row_ror:2 row_mask:0xf bank_mask:0xf
    s_nop 1
    v_add_f32_dpp v18, v18, v18 row_ror:4 row_mask:0xf bank_mask:0xf
    s_nop 1
    v_add_f32_dpp v18, v18, v18 row_ror:8 row_mask:0xf bank_mask:0xf
    v_rcp_f32 v18, v18
    s_nop 0
    v_mul_f32 v16, v16, v18
    ds_write_b32 v6, v16
    s_mov_b32 s57, 0
L_WO_nw:
    s_waitcnt vmcnt(4)
    ds_read_b64_tr_b16 v[128:129], v104 offset:0
    ds_read_b64_tr_b16 v[130:131], v104 offset:512
    ds_read_b64_tr_b16 v[132:133], v105 offset:0
    ds_read_b64_tr_b16 v[134:135], v105 offset:512
    ds_read_b64_tr_b16 v[136:137], v104 offset:2048
    ds_read_b64_tr_b16 v[138:139], v104 offset:2560
    ds_read_b64_tr_b16 v[140:141], v105 offset:2048
    ds_read_b64_tr_b16 v[142:143], v105 offset:2560
    s_branch L_WO_first
L_WO_loop:
    s_or_b32 s64, s64, s65
    s_cbranch_scc0 L_WO_sk1
    s_lshr_b32 s65, s64, 16
    s_or_b32 s64, s64, s65
    s_bitreplicate_b64_b32 s[64:65], s64
    s_bitreplicate_b64_b32 s[64:65], s64
    s_bitreplicate_b64_b32 exec, s64
    s_cbranch_execz L_WO_sk0
    buffer_load_dwordx4 v96, s[36:39], s54 offen offset:0 sc1 lds
L_WO_sk0:
    s_bitreplicate_b64_b32 exec, s65
    s_cbranch_execz L_WO_sk1
    buffer_load_dwordx4 v97, s[36:39], s54 offen offset:1024 sc1 lds
L_WO_sk1:
    s_or_b32 s66, s66, s67
    s_cbranch_scc0 L_WO_sk3
    s_lshr_b32 s67, s66, 16
    s_or_b32 s66, s66, s67
    s_bitreplicate_b64_b32 s[66:67], s66
    s_bitreplicate_b64_b32 s[66:67], s66
    s_bitreplicate_b64_b32 exec, s66
    s_cbranch_execz L_WO_sk2
    buffer_load_dwordx4 v96, s[36:39], s54 offen offset:2048 sc1 lds
L_WO_sk2:
    s_bitreplicate_b64_b32 exec, s67
    s_cbranch_execz L_WO_sk3
    buffer_load_dwordx4 v97, s[36:39], s54 offen offset:3072 sc1 lds
L_WO_sk3:
    s_mov_b64 exec, -1
L_WO_first:
    s_waitcnt vmcnt(0)
    ds_read_b128 v[160:163], v98 offset:0
    ds_read_b128 v[164:167], v99 offset:0
    ds_read_b128 v[168:171], v98 offset:2048
    ds_read_b128 v[172:175], v99 offset:2048
    ds_read_b128 v[20:23], v100
    ds_read_b128 v[24:27], v100 offset:64
    s_waitcnt lgkmcnt(5)
    v_lshl_add_u64 v[160:161], v[160:161], 0, v[108:109]
    v_lshl_add_u64 v[162:163], v[162:163], 0, v[110:111]
    s_waitcnt lgkmcnt(4)
    v_lshl_add_u64 v[164:165], v[164:165], 0, v[112:113]
    v_lshl_add_u64 v[166:167], v[166:167], 0, v[114:115]
    v_mfma_f32_16x16x32_bf16 v[176:179], v[160:163], v[128:131], 0
    v_or3_b32 v52, v160, v161, v162
    v_mfma_f32_16x16x32_bf16 v[180:183], v[160:163], v[132:135], 0
    v_or3_b32 v52, v52, v163, v164
    s_waitcnt lgkmcnt(3)
    v_lshl_add_u64 v[168:169], v[168:169], 0, v[108:109]
    v_lshl_add_u64 v[170:171], v[170:171], 0, v[110:111]
    v_mfma_f32_16x16x32_bf16 v[176:179], v[164:167], v[136:139], v[176:179]
    v_or3_b32 v52, v52, v165, v166
    v_mfma_f32_16x16x32_bf16 v[180:183], v[164:167], v[140:143], v[180:183]
    v_bitop3_b32 v52, v52, v167, 1 bitop3:0xa8
    v_cmp_ne_u32 s[64:65], 0, v52
    s_waitcnt lgkmcnt(2)
    v_lshl_add_u64 v[172:173], v[172:173], 0, v[112:113]
    v_lshl_add_u64 v[174:175], v[174:175], 0, v[114:115]
    v_mfma_f32_16x16x32_bf16 v[184:187], v[168:171], v[128:131], 0
    v_or3_b32 v53, v168, v169, v170
    v_mfma_f32_16x16x32_bf16 v[188:191], v[168:171], v[132:135], 0
    v_or3_b32 v53, v53, v171, v172
    v_mfma_f32_16x16x32_bf16 v[184:187], v[172:175], v[136:139], v[184:187]
    v_or3_b32 v53, v53, v173, v174
    v_mfma_f32_16x16x32_bf16 v[188:191], v[172:175], v[140:143], v[188:191]
    v_bitop3_b32 v53, v53, v175, 1 bitop3:0xa8
    v_cmp_ne_u32 s[66:67], 0, v53
    s_waitcnt lgkmcnt(0)
    v_cmp_eq_u32 vcc, -1, v23
    s_or_b64 s[68:69], s[64:65], s[66:67]
    s_or_b64 vcc, vcc, s[68:69]
    s_cbranch_scc0 L_WO_fin
    s_add_u32 s57, s57, 1
    s_and_b32 s35, s57, 127
    s_cbranch_scc1 L_nf_33
    buffer_wbl2 sc1
    s_waitcnt vmcnt(0)
L_nf_33:
    s_cmp_lt_u32 s57, 65536
    s_cbranch_scc1 L_WO_loop
L_WO_fin:
    v_pk_mul_f32 v[176:177], v[176:177], v[20:21]
    v_pk_mul_f32 v[180:181], v[180:181], v[20:21]
    v_pk_mul_f32 v[184:185], v[184:185], v[24:25]
    v_pk_mul_f32 v[188:189], v[188:189], v[24:25]
    v_pk_fma_f32 v[176:177], v[178:179], v[22:23], v[176:177]
    v_pk_fma_f32 v[180:181], v[182:183], v[22:23], v[180:181]
    v_pk_fma_f32 v[184:185], v[186:187], v[26:27], v[184:185]
    v_pk_fma_f32 v[188:189], v[190:191], v[26:27], v[188:189]
    v_add_f32 v48, v176, v177
    v_add_f32 v50, v184, v185
    v_add_f32 v49, v180, v181
    v_add_f32 v51, v188, v189
    v_permlane32_swap_b32 v48, v50
    s_nop 0
    v_permlane32_swap_b32 v49, v51
    v_pk_add_f32 v[48:49], v[48:49], v[50:51]
    s_nop 1
    v_permlane16_swap_b32 v48, v49
    v_add_f32 v48, v48, v49
    ds_write_b32 v101, v48
    s_waitcnt lgkmcnt(0)
    s_barrier
    s_cmp_lt_u32 s3, 1
    s_cbranch_scc0 L_WO_r
    ds_read_b128 v[16:19], v8
    ds_read_b128 v[20:23], v8 offset:1024
    s_waitcnt lgkmcnt(1)
    v_pk_add_f32 v[16:17], v[16:17], v[18:19]
    s_waitcnt lgkmcnt(0)
    v_pk_add_f32 v[20:21], v[20:21], v[22:23]
    v_pk_add_f32 v[16:17], v[16:17], v[20:21]
    v_add_f32 v16, v16, v17
    v_and_or_b32 v16, v16, v31, v30
    buffer_store_dword v16, v10, s[36:39], s58 offen sc1
L_TW:
    v_min_u32 v4, 55, v0
    v_lshrrev_b32 v5, 2, v4
    v_lshlrev_b32 v5, 8, v5
    v_and_b32 v6, 3, v4
    v_lshl_add_u32 v5, v6, 4, v5
    s_mul_i32 s58, s4, 7168
    s_add_u32 s58, s58, 720896
    s_mov_b32 s57, 0
    v_and_b32 v6, 3, v4
    v_lshlrev_b32 v6, 3, v6
    v_lshrrev_b32 v6, v6, s34
    v_and_b32 v6, 0xff, v6
L_TW_poll:
    buffer_load_ubyte v7, v5, s[36:39], s58 offen sc1
    s_waitcnt vmcnt(0)
    v_cmp_ne_u32 vcc, v6, v7
    s_cbranch_vccz L_TW_ok
    s_add_u32 s57, s57, 1
    s_and_b32 s35, s57, 127
    s_cbranch_scc1 L_nf_34
    buffer_wbl2 sc1
    s_waitcnt vmcnt(0)
L_nf_34:
    s_cmp_lt_u32 s57, 65536
    s_cbranch_scc1 L_TW_poll
L_TW_ok:
    s_branch L_done
L_notwo:
    s_cmp_lt_u32 s5, 28
    s_cbranch_scc0 L_RED
    s_mul_i32 s59, s71, 896
    s_mul_i32 s52, s6, 3584
    s_add_u32 s52, s52, s59
    s_add_u32 s52, s52, 720896
    s_add_u32 s53, s52, 7168
    s_add_u32 s54, s53, 7168
    s_add_u32 s55, s54, 7168
    v_mov_b32 v39, 0xff
    v_lshlrev_b32 v40, 5, v0
    v_add_u32 v40, 139520, v40
    v_mov_b32 v60, 163360
    s_mov_b32 s57, 0
L_f_wait:
    s_sleep 1
    ds_read_b32 v61, v60 offset:16
    s_waitcnt lgkmcnt(0)
    v_cmp_ne_u32 vcc, 4, v61
    s_cbranch_vccz L_f_go
    s_add_u32 s57, s57, 1
    s_cmp_lt_u32 s57, 65536
    s_cbranch_scc1 L_f_wait
L_f_go:
    s_mov_b32 s57, 0
L_LN_poll:
    buffer_load_dwordx4 v[128:131], v84, s[36:39], s52 offen sc1
    buffer_load_dwordx4 v[132:135], v84, s[36:39], s53 offen sc1
    buffer_load_dwordx4 v[136:139], v84, s[36:39], s54 offen sc1
    buffer_load_dwordx4 v[140:143], v84, s[36:39], s55 offen sc1
    s_waitcnt vmcnt(2)
    v_xor_b32 v128, v87, v128
    v_xor_b32 v132, v87, v132
    v_pk_add_f32 v[22:23], v[130:131], v[134:135]
    v_pk_add_f32 v[20:21], v[128:129], v[132:133]
    s_waitcnt vmcnt(1)
    v_xor_b32 v136, v87, v136
    v_pk_add_f32 v[22:23], v[22:23], v[138:139]
    v_pk_add_f32 v[20:21], v[20:21], v[136:137]
    v_or3_b32 v24, v128, v132, v136
    s_waitcnt vmcnt(0)
    v_xor_b32 v140, v87, v140
    v_pk_add_f32 v[22:23], v[22:23], v[142:143]
    v_pk_add_f32 v[20:21], v[20:21], v[140:141]
    v_bitop3_b32 v24, v24, v140, v39 bitop3:0xa8
    v_cmp_ne_u32 vcc, 0, v24
    s_cbranch_vccz L_LN_got
    s_add_u32 s57, s57, 1
    s_and_b32 s35, s57, 127
    s_cbranch_scc1 L_nf_35
    buffer_wbl2 sc1
    s_waitcnt vmcnt(0)
L_nf_35:
    s_cmp_lt_u32 s57, 65536
    s_cbranch_scc1 L_LN_poll
L_LN_got:
    v_permlane32_swap_b32 v20, v22
    v_permlane32_swap_b32 v21, v23
    v_pk_add_f32 v[20:21], v[20:21], v[22:23]
    v_pk_fma_f32 v[20:21], v[20:21], v[78:79], v[76:77]
    v_pk_mul_f32 v[22:23], v[20:21], v[80:81]
    v_cvt_pk_bf16_f32 v24, v22, v23
    ds_write_b32 v85, v24
    v_lshlrev_b32 v26, 16, v24
    v_and_b32 v27, 0xffff0000, v24
    v_pk_add_f32 v[22:23], v[22:23], v[26:27] neg_lo:[0,1] neg_hi:[0,1]
    v_cvt_pk_bf16_f32 v25, v22, v23
    ds_write_b32 v85, v25 offset:1040
    ds_write_b64 v86, v[20:21]
    s_waitcnt lgkmcnt(0)
    s_barrier
    s_cmp_eq_u32 s3, 4
    s_cbranch_scc0 L_done
    ds_read_b128 v[24:27], v40
    ds_read_b128 v[28:31], v40 offset:16
    v_mov_b32 v5, 141824
    v_mov_b32 v33, 0x3727c5ac
    s_waitcnt lgkmcnt(1)
    v_pk_add_f32 v[44:45], v[24:25], v[26:27]
    v_pk_mul_f32 v[46:47], v[24:25], v[24:25]
    v_pk_fma_f32 v[46:47], v[26:27], v[26:27], v[46:47]
    s_waitcnt lgkmcnt(0)
    v_pk_add_f32 v[44:45], v[44:45], v[28:29]
    v_pk_fma_f32 v[46:47], v[28:29], v[28:29], v[46:47]
    v_pk_add_f32 v[44:45], v[44:45], v[30:31]
    v_pk_fma_f32 v[46:47], v[30:31], v[30:31], v[46:47]
    v_add_f32 v44, v44, v45
    v_add_f32 v46, v46, v47
    s_nop 1
    v_permlane32_swap_b32 v44, v46
    v_add_f32 v44, v44, v46
    s_nop 1
    v_add_f32_dpp v44, v44, v44 row_ror:8 row_mask:0xf bank_mask:0xf
    s_nop 1
    v_add_f32_dpp v44, v44, v44 row_ror:4 row_mask:0xf bank_mask:0xf
    s_nop 1
    v_add_f32_dpp v44, v44, v44 row_ror:2 row_mask:0xf bank_mask:0xf
    s_nop 1
    v_add_f32_dpp v44, v44, v44 row_ror:1 row_mask:0xf bank_mask:0xf
    s_nop 1
    v_add_f32_dpp v44, v44, v44 row_bcast:15 row_mask:0xa bank_mask:0xf
    v_mul_f32 v44, 0x3b124925, v44
    s_nop 0
    v_readlane_b32 s59, v44, 31
    s_mov_b32 exec_lo, 0
    s_brev_b32 exec_hi, 1
    v_fma_f32 v46, -s59, s59, v44
    v_max_f32 v46, 0, v46
    v_add_f32 v46, v33, v46
    v_rsq_f32 v46, v46
    s_nop 0
    v_mul_f32 v47, -s59, v46
    ds_write_b64 v5, v[46:47]
    s_waitcnt lgkmcnt(0)
    s_mov_b64 exec, -1
    s_barrier
    s_branch L_done
L_FX:
    s_sub_u32 s52, s7, 7
    s_mul_i32 s53, s4, 7
    s_add_u32 s62, s52, s53
    s_mov_b32 s40, s20
    s_mov_b32 s41, s21
    s_mov_b32 s42, 1605632
    s_mov_b32 s43, 0x20000
    s_mov_b32 s44, s22
    s_mov_b32 s45, s23
    s_mov_b32 s46, 1605632
    s_mov_b32 s47, 0x20000
    s_mov_b32 s48, s24
    s_mov_b32 s49, s25
    s_mov_b32 s50, 1605632
    s_mov_b32 s51, 0x20000
    v_lshrrev_b32 v4, 2, v0
    v_mul_u32_u24 v4, 3584, v4
    v_and_b32 v5, 1, v1
    v_lshlrev_b32 v5, 1, v5
    v_and_b32 v6, 3, v0
    v_xor_b32 v5, v5, v6
    v_lshl_add_u32 v4, v5, 4, v4
    s_and_b32 s52, s62, 1
    s_lshl_b32 s52, s52, 0
    s_lshl_b32 s53, s6, 1
    s_add_u32 s52, s52, s53
    s_mul_i32 s53, s71, 114688
    s_lshl_b32 s54, s62, 6
    s_add_u32 s53, s53, s54
    s_lshl_b32 s56, s71, 14
    s_lshl_b32 s57, s71, 6
    s_add_u32 s57, s57, 135168
    v_and_b32 v20, 1, v2
    v_mul_u32_u24 v20, 1040, v20
    v_lshl_add_u32 v20, v1, 4, v20
    v_add_u32 v20, s57, v20
    v_mul_u32_u24 v5, 7168, v1
    v_lshl_add_u32 v5, v2, 4, v5
    s_movk_i32 s68, 0xff
    s_cmp_eq_u32 s71, 3
    s_cselect_b32 s68, s68, 0xffff
    s_mov_b32 s69, s68
    s_lshl_b32 s64, s68, 16
    s_or_b32 s64, s64, s68
    s_mov_b32 s65, s64
    v_mov_b32 v6, 0x10000000
    v_cndmask_b32 v5, v6, v5, s[64:65]
    s_mul_i32 s96, s62, 28672
    s_lshl_b32 s97, s71, 8
    s_add_u32 s96, s96, s97
    s_add_u32 s97, s96, 3584
    s_mov_b32 s60, 0x05040100
    s_mov_b32 s61, 0x07060302
    v_lshrrev_b32 v12, 1, v1
    v_lshlrev_b32 v12, 10, v12
    v_and_b32 v62, 1, v1
    v_mul_u32_u24 v62, 288, v62
    v_add_u32 v12, v12, v62
    v_lshrrev_b32 v62, 2, v2
    v_lshl_add_u32 v12, v62, 6, v12
    v_and_b32 v62, 3, v2
    v_lshl_add_u32 v12, v62, 3, v12
    v_add_u32 v12, s56, v12
    v_xor_b32 v13, 32, v12
    v_lshlrev_b32 v7, 4, v0
    s_lshl_b32 s59, s71, 2
    s_add_u32 s59, s59, 131072
    v_add_u32 v7, s59, v7
    v_and_b32 v9, 7, v2
    s_lshl_b32 s59, s6, 2
    v_xor_b32 v8, 0, v9
    v_lshl_add_u32 v8, v1, 3, v8
    v_lshlrev_b32 v8, 4, v8
    v_add_u32 v8, 131072, v8
    v_lshrrev_b32 v10, 3, v2
    v_lshlrev_b32 v10, 14, v10
    v_lshl_add_u32 v10, v1, 12, v10
    v_lshl_add_u32 v10, v9, 4, v10
    s_mul_i32 s58, s6, 114688
    s_lshl_b32 s59, s62, 7
    s_add_u32 s58, s58, s59
    s_lshl_b32 s59, s71, 15
    s_add_u32 s58, s58, s59
    s_add_u32 s58, s58, 491520
    s_mov_b32 s57, 0xbfb8aa3b
    v_and_b32 v21, 3, v2
    v_lshlrev_b32 v21, 3, v21
    v_lshrrev_b32 v21, v21, s34
    v_and_b32 v21, 0xff, v21
    v_mov_b32 v22, 0xffffff00
    v_mov_b32 v29, s34
    s_lshl_b32 s63, s4, 4
    s_add_u32 s63, s63, s5
    s_lshl_b32 s63, s63, 2
    s_add_u32 s63, s63, s71
    s_lshl_b32 s63, s63, 2
    s_add_u32 s63, s63, 139040
    s_mov_b32 s64, 0xffff0000
    s_mov_b32 s65, 0xffff0000
    s_mov_b32 s66, 0x0
    s_mov_b32 s67, 0xffffffff
    s_waitcnt vmcnt(4)
    s_barrier
    buffer_load_dwordx4 v[192:195], v5, s[48:51], s96 offen offset:0
    buffer_load_dwordx4 v[196:199], v5, s[48:51], s96 offen offset:896
    buffer_load_dwordx4 v[200:203], v5, s[48:51], s96 offen offset:1792
    buffer_load_dwordx4 v[204:207], v5, s[48:51], s96 offen offset:2688
    buffer_load_dwordx4 v[208:211], v5, s[48:51], s97 offen offset:0
    buffer_load_dwordx4 v[212:215], v5, s[48:51], s97 offen offset:896
    s_waitcnt vmcnt(6)
    s_barrier
    s_barrier
    buffer_load_dwordx4 v[216:219], v5, s[48:51], s97 offen offset:1792
    buffer_load_dwordx4 v[220:223], v5, s[48:51], s97 offen offset:2688
    s_add_u32 s54, s52, 0
    s_and_b32 s54, s54, 3
    s_lshl_b32 s55, s54, 8
    v_add_u32 v16, s55, v20
    s_mul_i32 s54, s54, 458752
    s_add_u32 s54, s54, s53
    s_add_u32 s55, s54, 57344
    s_add_u32 m0, s56, 0
    s_nop 0
    buffer_load_dwordx4 v4, s[40:43], s54 offen  lds
    s_add_u32 m0, s56, 8192
    s_nop 0
    buffer_load_dwordx4 v4, s[44:47], s54 offen  lds
    s_add_u32 m0, s56, 1024
    s_nop 0
    buffer_load_dwordx4 v4, s[40:43], s55 offen  lds
    s_add_u32 m0, s56, 9216
    s_nop 0
    buffer_load_dwordx4 v4, s[44:47], s55 offen  lds
    s_waitcnt vmcnt(4)
    v_perm_b32 v224, v196, v192, s60
    v_perm_b32 v228, v196, v192, s61
    v_perm_b32 v225, v204, v200, s60
    v_perm_b32 v229, v204, v200, s61
    v_perm_b32 v226, v212, v208, s60
    v_perm_b32 v230, v212, v208, s61
    v_perm_b32 v227, v220, v216, s60
    v_perm_b32 v231, v220, v216, s61
    v_perm_b32 v232, v197, v193, s60
    v_perm_b32 v236, v197, v193, s61
    v_perm_b32 v233, v205, v201, s60
    v_perm_b32 v237, v205, v201, s61
    v_perm_b32 v234, v213, v209, s60
    v_perm_b32 v238, v213, v209, s61
    v_perm_b32 v235, v221, v217, s60
    v_perm_b32 v239, v221, v217, s61
    v_perm_b32 v240, v198, v194, s60
    v_perm_b32 v244, v198, v194, s61
    v_perm_b32 v241, v206, v202, s60
    v_perm_b32 v245, v206, v202, s61
    v_perm_b32 v242, v214, v210, s60
    v_perm_b32 v246, v214, v210, s61
    v_perm_b32 v243, v222, v218, s60
    v_perm_b32 v247, v222, v218, s61
    v_perm_b32 v248, v199, v195, s60
    v_perm_b32 v252, v199, v195, s61
    v_perm_b32 v249, v207, v203, s60
    v_perm_b32 v253, v207, v203, s61
    v_perm_b32 v250, v215, v211, s60
    v_perm_b32 v254, v215, v211, s61
    v_perm_b32 v251, v223, v219, s60
    v_perm_b32 v255, v223, v219, s61
    s_add_u32 s54, s52, 1
    s_and_b32 s54, s54, 3
    s_lshl_b32 s55, s54, 8
    v_add_u32 v17, s55, v20
    s_mul_i32 s54, s54, 458752
    s_add_u32 s54, s54, s53
    s_add_u32 s55, s54, 57344
    s_add_u32 m0, s56, 2048
    s_nop 0
    buffer_load_dwordx4 v4, s[40:43], s54 offen  lds
    s_add_u32 m0, s56, 10240
    s_nop 0
    buffer_load_dwordx4 v4, s[44:47], s54 offen  lds
    s_add_u32 m0, s56, 3072
    s_nop 0
    buffer_load_dwordx4 v4, s[40:43], s55 offen  lds
    s_add_u32 m0, s56, 11264
    s_nop 0
    buffer_load_dwordx4 v4, s[44:47], s55 offen  lds
    s_add_u32 s54, s52, 2
    s_and_b32 s54, s54, 3
    s_lshl_b32 s55, s54, 8
    v_add_u32 v18, s55, v20
    s_mul_i32 s54, s54, 458752
    s_add_u32 s54, s54, s53
    s_add_u32 s55, s54, 57344
    s_add_u32 m0, s56, 4096
    s_nop 0
    buffer_load_dwordx4 v4, s[40:43], s54 offen  lds
    s_add_u32 m0, s56, 12288
    s_nop 0
    buffer_load_dwordx4 v4, s[44:47], s54 offen  lds
    ds_read_b128 v[96:99], v16 offset:2080
    s_waitcnt vmcnt(6)
    ds_read_b64_tr_b16 v[128:129], v12 offset:0
    ds_read_b64_tr_b16 v[130:131], v12 offset:512
    ds_read_b64_tr_b16 v[132:133], v13 offset:0
    ds_read_b64_tr_b16 v[134:135], v13 offset:512
    ds_read_b64_tr_b16 v[160:161], v12 offset:8192
    ds_read_b64_tr_b16 v[162:163], v12 offset:8704
    ds_read_b64_tr_b16 v[164:165], v13 offset:8192
    ds_read_b64_tr_b16 v[166:167], v13 offset:8704
    s_waitcnt lgkmcnt(0)
    v_mfma_f32_16x16x32_bf16 v[32:35], v[96:99], v[128:131], 0
    v_mfma_f32_16x16x32_bf16 v[36:39], v[96:99], v[132:135], 0
    v_mfma_f32_16x16x32_bf16 v[40:43], v[96:99], v[160:163], 0
    v_mfma_f32_16x16x32_bf16 v[44:47], v[96:99], v[164:167], 0
    s_add_u32 m0, s56, 5120
    s_nop 0
    buffer_load_dwordx4 v4, s[40:43], s55 offen  lds
    s_add_u32 m0, s56, 13312
    s_nop 0
    buffer_load_dwordx4 v4, s[44:47], s55 offen  lds
    s_add_u32 s54, s52, 3
    s_and_b32 s54, s54, 3
    s_lshl_b32 s55, s54, 8
    v_add_u32 v19, s55, v20
    s_mul_i32 s54, s54, 458752
    s_add_u32 s54, s54, s53
    s_add_u32 s55, s54, 57344
    s_add_u32 m0, s56, 6144
    s_nop 0
    buffer_load_dwordx4 v4, s[40:43], s54 offen  lds
    s_add_u32 m0, s56, 14336
    s_nop 0
    buffer_load_dwordx4 v4, s[44:47], s54 offen  lds
    ds_read_b128 v[100:103], v17 offset:2080
    s_waitcnt vmcnt(6)
    ds_read_b64_tr_b16 v[136:137], v12 offset:2048
    ds_read_b64_tr_b16 v[138:139], v12 offset:2560
    ds_read_b64_tr_b16 v[140:141], v13 offset:2048
    ds_read_b64_tr_b16 v[142:143], v13 offset:2560
    ds_read_b64_tr_b16 v[168:169], v12 offset:10240
    ds_read_b64_tr_b16 v[170:171], v12 offset:10752
    ds_read_b64_tr_b16 v[172:173], v13 offset:10240
    ds_read_b64_tr_b16 v[174:175], v13 offset:10752
    s_waitcnt lgkmcnt(0)
    v_mfma_f32_16x16x32_bf16 v[32:35], v[100:103], v[136:139], v[32:35]
    v_mfma_f32_16x16x32_bf16 v[36:39], v[100:103], v[140:143], v[36:39]
    v_mfma_f32_16x16x32_bf16 v[40:43], v[100:103], v[168:171], v[40:43]
    v_mfma_f32_16x16x32_bf16 v[44:47], v[100:103], v[172:175], v[44:47]
    s_add_u32 m0, s56, 7168
    s_nop 0
    buffer_load_dwordx4 v4, s[40:43], s55 offen  lds
    s_add_u32 m0, s56, 15360
    s_nop 0
    buffer_load_dwordx4 v4, s[44:47], s55 offen  lds
    ds_read_b128 v[104:107], v18 offset:2080
    s_waitcnt vmcnt(4)
    v_mov_b32 v23, 163360
    v_mov_b32 v24, 1
    s_mov_b64 exec, 1
    ds_add_u32 v23, v24 offset:16
    s_mov_b64 exec, -1
    ds_read_b64_tr_b16 v[144:145], v12 offset:4096
    ds_read_b64_tr_b16 v[146:147], v12 offset:4608
    ds_read_b64_tr_b16 v[148:149], v13 offset:4096
    ds_read_b64_tr_b16 v[150:151], v13 offset:4608
    ds_read_b64_tr_b16 v[176:177], v12 offset:12288
    ds_read_b64_tr_b16 v[178:179], v12 offset:12800
    ds_read_b64_tr_b16 v[180:181], v13 offset:12288
    ds_read_b64_tr_b16 v[182:183], v13 offset:12800
    s_waitcnt lgkmcnt(0)
    v_mfma_f32_16x16x32_bf16 v[32:35], v[104:107], v[144:147], v[32:35]
    v_mfma_f32_16x16x32_bf16 v[36:39], v[104:107], v[148:151], v[36:39]
    v_mfma_f32_16x16x32_bf16 v[40:43], v[104:107], v[176:179], v[40:43]
    v_mfma_f32_16x16x32_bf16 v[44:47], v[104:107], v[180:183], v[44:47]
    ds_read_b128 v[108:111], v19 offset:2080
    s_waitcnt vmcnt(0)
    ds_read_b64_tr_b16 v[152:153], v12 offset:6144
    ds_read_b64_tr_b16 v[154:155], v12 offset:6656
    ds_read_b64_tr_b16 v[156:157], v13 offset:6144
    ds_read_b64_tr_b16 v[158:159], v13 offset:6656
    ds_read_b64_tr_b16 v[184:185], v12 offset:14336
    ds_read_b64_tr_b16 v[186:187], v12 offset:14848
    ds_read_b64_tr_b16 v[188:189], v13 offset:14336
    ds_read_b64_tr_b16 v[190:191], v13 offset:14848
    s_waitcnt lgkmcnt(0)
    v_mfma_f32_16x16x32_bf16 v[32:35], v[108:111], v[152:155], v[32:35]
    v_mfma_f32_16x16x32_bf16 v[36:39], v[108:111], v[156:159], v[36:39]
    v_mfma_f32_16x16x32_bf16 v[40:43], v[108:111], v[184:187], v[40:43]
    v_mfma_f32_16x16x32_bf16 v[44:47], v[108:111], v[188:191], v[44:47]
    s_nop 5
    v_cndmask_b32 v48, v32, v36, s[64:65]
    v_cndmask_b32 v49, v33, v37, s[64:65]
    v_cndmask_b32 v50, v40, v44, s[64:65]
    v_cndmask_b32 v51, v41, v45, s[64:65]
    v_cndmask_b32 v48, v48, v50, s[66:67]
    v_cndmask_b32 v49, v49, v51, s[66:67]
    ds_write2st64_b32 v7, v48, v49 offset0:8 offset1:12
    v_mov_b32 v11, 141824
    s_waitcnt lgkmcnt(0)
    s_barrier
    ds_read_b128 v[96:99], v16 offset:0
    ds_read_b128 v[100:103], v17 offset:0
    ds_read_b128 v[104:107], v18 offset:0
    ds_read_b128 v[108:111], v19 offset:0
    ds_read_b128 v[112:115], v8 offset:2048
    ds_read_b128 v[116:119], v8 offset:3072
    ds_read_b128 v[120:123], v8 offset:2560
    ds_read_b128 v[124:127], v8 offset:3584
    s_waitcnt lgkmcnt(7)
    v_mfma_f32_16x16x32_bf16 v[32:35], v[96:99], v[128:131], 0
    v_mfma_f32_16x16x32_bf16 v[36:39], v[96:99], v[132:135], 0
    v_mfma_f32_16x16x32_bf16 v[40:43], v[96:99], v[160:163], 0
    v_mfma_f32_16x16x32_bf16 v[44:47], v[96:99], v[164:167], 0
    s_waitcnt lgkmcnt(6)
    v_mfma_f32_16x16x32_bf16 v[32:35], v[100:103], v[136:139], v[32:35]
    v_mfma_f32_16x16x32_bf16 v[36:39], v[100:103], v[140:143], v[36:39]
    v_mfma_f32_16x16x32_bf16 v[40:43], v[100:103], v[168:171], v[40:43]
    v_mfma_f32_16x16x32_bf16 v[44:47], v[100:103], v[172:175], v[44:47]
    s_waitcnt lgkmcnt(5)
    v_mfma_f32_16x16x32_bf16 v[32:35], v[104:107], v[144:147], v[32:35]
    v_mfma_f32_16x16x32_bf16 v[36:39], v[104:107], v[148:151], v[36:39]
    v_mfma_f32_16x16x32_bf16 v[40:43], v[104:107], v[176:179], v[40:43]
    v_mfma_f32_16x16x32_bf16 v[44:47], v[104:107], v[180:183], v[44:47]
    s_waitcnt lgkmcnt(4)
    v_mfma_f32_16x16x32_bf16 v[32:35], v[108:111], v[152:155], v[32:35]
    v_mfma_f32_16x16x32_bf16 v[36:39], v[108:111], v[156:159], v[36:39]
    v_mfma_f32_16x16x32_bf16 v[40:43], v[108:111], v[184:187], v[40:43]
    v_mfma_f32_16x16x32_bf16 v[44:47], v[108:111], v[188:191], v[44:47]
    s_waitcnt lgkmcnt(0)
    v_pk_add_f32 v[112:113], v[112:113], v[114:115]
    v_pk_add_f32 v[116:117], v[116:117], v[118:119]
    v_pk_add_f32 v[120:121], v[120:121], v[122:123]
    v_pk_add_f32 v[124:125], v[124:125], v[126:127]
    v_add_f32 v32, v32, v33
    v_add_f32 v36, v36, v37
    v_add_f32 v40, v40, v41
    v_cndmask_b32 v48, v32, v36, s[64:65]
    v_add_f32 v44, v44, v45
    v_cndmask_b32 v50, v40, v44, s[64:65]
    v_cndmask_b32 v48, v48, v50, s[66:67]
    ds_write_b32 v7, v48
    v_add_f32 v52, v112, v113
    v_add_f32 v54, v116, v117
    v_add_f32 v53, v120, v121
    v_add_f32 v55, v124, v125
    s_waitcnt lgkmcnt(0)
    s_barrier
    ds_read_b64 v[48:49], v11
    ds_read_b128 v[32:35], v8
    ds_read_b128 v[40:43], v8 offset:512
    s_waitcnt lgkmcnt(1)
    v_pk_add_f32 v[32:33], v[32:33], v[34:35]
    v_fma_f32 v54, v49, v52, v54
    v_add_f32 v16, v32, v33
    v_fma_f32 v55, v49, v53, v55
    v_fma_f32 v16, v16, v48, v54
    v_mul_f32 v17, s57, v16
    v_exp_f32 v17, v17
    s_waitcnt lgkmcnt(0)
    v_pk_add_f32 v[40:41], v[40:41], v[42:43]
    v_add_f32 v17, 1.0, v17
    v_rcp_f32 v17, v17
    v_add_f32 v20, v40, v41
    v_fma_f32 v20, v20, v48, v55
    v_mul_f32 v16, v16, v17
    v_mul_f32 v16, v16, v20
    s_nop 1
    v_mov_b32_dpp v17, v16 row_ror:15 row_mask:0xf bank_mask:0xf
    v_cvt_pk_bf16_f32 v24, v16, v17
    s_nop 1
    v_mov_b32_dpp v25, v24 row_ror:14 row_mask:0xf bank_mask:0xf
    v_mov_b32_dpp v26, v24 row_ror:12 row_mask:0xf bank_mask:0xf
    v_mov_b32_dpp v27, v24 row_ror:10 row_mask:0xf bank_mask:0xf
    s_nop 1
    v_mfma_f32_16x16x32_bf16 v[64:67], v[24:27], v[224:227], 0
    v_mfma_f32_16x16x32_bf16 v[80:83], v[24:27], v[240:243], 0
    v_mfma_f32_16x16x32_bf16 v[68:71], v[24:27], v[228:231], 0
    v_mfma_f32_16x16x32_bf16 v[84:87], v[24:27], v[244:247], 0
    v_mfma_f32_16x16x32_bf16 v[72:75], v[24:27], v[232:235], 0
    v_mfma_f32_16x16x32_bf16 v[88:91], v[24:27], v[248:251], 0
    v_mfma_f32_16x16x32_bf16 v[76:79], v[24:27], v[236:239], 0
    v_mfma_f32_16x16x32_bf16 v[92:95], v[24:27], v[252:255], 0
    s_nop 1
    v_cndmask_b32 v16, v64, v80, s[66:67]
    v_and_or_b32 v16, v16, v22, v21
    v_cndmask_b32 v17, v68, v84, s[66:67]
    s_nop 0
    v_cndmask_b32 v18, v72, v88, s[66:67]
    s_nop 0
    v_cndmask_b32 v19, v76, v92, s[66:67]
    s_mov_b64 exec, s[68:69]
    buffer_store_dwordx4 v[16:19], v10, s[36:39], s58 offen sc1
    s_mov_b64 exec, -1
    s_mov_b64 exec, 1
    buffer_store_dword v29, off, s[36:39], s63
    s_mov_b64 exec, -1
    s_branch L_done
L_RED:
    s_cmp_eq_u32 s3, 4
    s_cbranch_scc0 L_done
    s_branch L_TW
L_WO_r:
    s_sub_u32 s62, s3, 4
    s_lshl_b32 s52, s4, 1
    s_or_b32 s52, s52, s62
    s_cmp_lt_u32 s52, 2
    s_cbranch_scc0 L_done
    s_lshl_b32 s52, s5, 1
    s_add_u32 s62, s62, s52
    s_cmp_ge_u32 s62, 14
    s_cselect_b32 s52, 1, 0
    s_mul_i32 s53, s52, 14
    s_sub_u32 s53, s62, s53
    s_lshr_b32 s63, s53, 1
    s_lshl_b32 s63, s63, 6
    s_and_b32 s54, s53, 1
    s_lshl_b32 s54, s54, 2
    s_add_u32 s63, s63, s54
    s_mov_b32 s40, s8
    s_mov_b32 s41, s9
    s_mov_b32 s42, 1792
    s_mov_b32 s43, 0x20000
    s_mov_b32 s44, s30
    s_mov_b32 s45, s31
    s_mov_b32 s46, 1792
    s_mov_b32 s47, 0x20000
    v_and_b32 v4, 7, v0
    v_lshl_add_u32 v6, v4, 3, v1
    v_add_u32 v6, s63, v6
    v_lshlrev_b32 v5, 1, v6
    s_mul_i32 s54, s52, 896
    buffer_load_ushort v16, v5, s[40:43], s54 offen
    buffer_load_ushort v17, v5, s[44:47], s54 offen
    v_and_b32 v33, 15, v6
    v_lshlrev_b32 v33, 1, v33
    v_lshrrev_b32 v33, v33, s34
    v_lshlrev_b32 v6, 2, v6
    s_mul_i32 s55, s52, 10752
    s_add_u32 s55, s55, 7680
    s_add_u32 s56, s55, 21504
    s_add_u32 s58, s55, 5376
    s_add_u32 s61, s56, 5376
    v_lshrrev_b32 v7, 3, v0
    v_mul_u32_u24 v8, 7168, v7
    v_lshrrev_b32 v7, 1, v4
    v_lshl_add_u32 v8, v7, 7, v8
    v_and_b32 v7, 1, v4
    v_lshl_add_u32 v8, v7, 5, v8
    v_lshlrev_b32 v9, 4, v0
    s_mul_i32 s59, s52, 3584
    s_lshr_b32 s60, s53, 1
    s_lshl_b32 s60, s60, 9
    s_add_u32 s59, s59, s60
    s_and_b32 s60, s53, 1
    s_lshl_b32 s60, s60, 4
    s_add_u32 s59, s59, s60
    s_add_u32 s59, s59, 720896
    s_lshl_b32 s60, s62, 13
    s_add_u32 s60, s60, 491520
    s_mov_b32 s57, 0
L_RED_pollm:
    buffer_load_dword v18, v6, s[36:39], s55 offen sc1
    buffer_load_dword v19, v6, s[36:39], s56 offen sc1
    buffer_load_dword v20, v6, s[36:39], s58 offen sc1
    buffer_load_dword v21, v6, s[36:39], s61 offen sc1
    s_waitcnt vmcnt(0)
    v_xor_b32 v22, v18, v33
    v_bitop3_b32 v22, v22, v19, v33 bitop3:0xf6
    v_bitop3_b32 v22, v22, v20, v33 bitop3:0xf6
    v_bitop3_b32 v22, v22, v21, v33 bitop3:0xf6
    v_and_b32 v22, 3, v22
    v_cmp_ne_u32 vcc, 0, v22
    s_cbranch_vccz L_RED_gotm
    s_add_u32 s57, s57, 1
    s_and_b32 s35, s57, 127
    s_cbranch_scc1 L_nf_36
    buffer_wbl2 sc1
    s_waitcnt vmcnt(0)
L_nf_36:
    s_cmp_lt_u32 s57, 65536
    s_cbranch_scc1 L_RED_pollm
L_RED_gotm:
    s_mov_b32 s66, 0xff00ff
    s_mov_b32 s67, 0xff00ff
    v_and_b32 v18, -4, v18
    v_and_b32 v19, -4, v19
    v_and_b32 v20, -4, v20
    v_and_b32 v21, -4, v21
    v_add_f32 v18, v18, v19
    v_add_f32 v20, v20, v21
    v_lshlrev_b32 v16, 16, v16
    v_cvt_pk_bf16_f32 v22, v18, v20
    v_lshlrev_b32 v18, 16, v22
    v_and_b32 v20, 0xffff0000, v22
    s_and_b32 s35, s53, 1
    v_lshl_add_u32 v34, v4, 1, s35
    v_and_b32 v34, 3, v34
    v_lshlrev_b32 v34, 3, v34
    v_lshrrev_b32 v34, v34, s34
    v_and_b32 v34, 0xff, v34
    v_and_b32 v35, 3, v4
    v_lshlrev_b32 v35, 3, v35
    v_lshrrev_b32 v35, v35, s34
    v_and_b32 v35, 0xff, v35
    v_mov_b32 v39, 0xff
    s_mov_b32 s57, 0
L_RED_pollb:
    buffer_load_dwordx4 v[24:27], v8, s[36:39], s59 offen sc1
    s_waitcnt vmcnt(0)
    v_xor_b32 v24, v34, v24
    v_and_b32 v28, v39, v24
    v_cmp_ne_u32 vcc, 0, v28
    s_cbranch_vccz L_RED_gotb
    s_add_u32 s57, s57, 1
    s_and_b32 s35, s57, 127
    s_cbranch_scc1 L_nf_37
    buffer_wbl2 sc1
    s_waitcnt vmcnt(0)
L_nf_37:
    s_cmp_lt_u32 s57, 65536
    s_cbranch_scc1 L_RED_pollb
L_RED_gotb:
    s_cmp_eq_u32 s62, 0
    s_cbranch_scc0 L_RED_noe
    v_mov_b32 v33, s34
    s_mov_b64 exec, 1
    buffer_store_dword v33, off, s[36:39], 0 sc1
    s_mov_b64 exec, -1
L_RED_noe:
    v_permlane32_swap_b32 v24, v26
    v_permlane32_swap_b32 v25, v27
    v_add_f32 v24, v24, v26
    v_add_f32 v25, v25, v27
    s_nop 1
    v_permlane16_swap_b32 v24, v25
    v_add_f32 v24, v24, v25
    s_nop 1
    v_add_f32_dpp v24, v24, v24 row_ror:8 row_mask:0xf bank_mask:0xf
    v_fmac_f32 v16, v24, v18
    s_mov_b32 s57, 0
    s_add_u32 s61, s60, 4096
    v_min_u32 v10, 55, v0
    v_lshlrev_b32 v10, 2, v10
    s_lshl_b32 s63, s4, 8
    s_add_u32 s63, s63, 139264
L_RED_hint:
    buffer_load_dword v11, v10, s[36:39], s63 offen sc1
    s_add_u32 s57, s57, 1
    s_waitcnt vmcnt(0)
    v_cmp_ne_u32 vcc, s34, v11
    s_cbranch_vccz L_RED_hok
    s_cmp_lt_u32 s57, 64
    s_cbranch_scc1 L_RED_hint
L_RED_hok:
    s_mov_b32 s57, 0
L_RED_pollc:
    buffer_load_dwordx4 v[64:67], v9, s[36:39], s60 offen offset:0 sc1
    buffer_load_dwordx4 v[68:71], v9, s[36:39], s60 offen offset:1024 sc1
    buffer_load_dwordx4 v[72:75], v9, s[36:39], s60 offen offset:2048 sc1
    buffer_load_dwordx4 v[76:79], v9, s[36:39], s60 offen offset:3072 sc1
    buffer_load_dwordx4 v[80:83], v9, s[36:39], s61 offen offset:0 sc1
    buffer_load_dwordx4 v[84:87], v9, s[36:39], s61 offen offset:1024 sc1
    buffer_load_dwordx4 v[88:91], v9, s[36:39], s61 offen offset:2048 sc1
    s_waitcnt vmcnt(5)
    v_xor_b32 v64, v35, v64
    v_xor_b32 v68, v35, v68
    v_pk_add_f32 v[26:27], v[66:67], v[70:71]
    v_pk_add_f32 v[24:25], v[64:65], v[68:69]
    v_or_b32 v28, v64, v68
    s_waitcnt vmcnt(4)
    v_xor_b32 v72, v35, v72
    v_pk_add_f32 v[26:27], v[26:27], v[74:75]
    v_pk_add_f32 v[24:25], v[24:25], v[72:73]
    s_waitcnt vmcnt(3)
    v_xor_b32 v76, v35, v76
    v_pk_add_f32 v[26:27], v[26:27], v[78:79]
    v_pk_add_f32 v[24:25], v[24:25], v[76:77]
    v_or3_b32 v28, v28, v72, v76
    s_waitcnt vmcnt(2)
    v_xor_b32 v80, v35, v80
    v_pk_add_f32 v[26:27], v[26:27], v[82:83]
    v_pk_add_f32 v[24:25], v[24:25], v[80:81]
    s_waitcnt vmcnt(1)
    v_xor_b32 v84, v35, v84
    v_pk_add_f32 v[26:27], v[26:27], v[86:87]
    v_pk_add_f32 v[24:25], v[24:25], v[84:85]
    v_or3_b32 v28, v28, v80, v84
    s_waitcnt vmcnt(0)
    v_xor_b32 v88, v35, v88
    v_pk_add_f32 v[26:27], v[26:27], v[90:91]
    v_pk_add_f32 v[24:25], v[24:25], v[88:89]
    v_bitop3_b32 v28, v28, v88, v39 bitop3:0xa8
    v_cmp_ne_u32 vcc, 0, v28
    s_cbranch_vccz L_RED_gotc
    s_add_u32 s57, s57, 1
    s_and_b32 s35, s57, 127
    s_cbranch_scc1 L_nf_38
    buffer_wbl2 sc1
    s_waitcnt vmcnt(0)
L_nf_38:
    s_cmp_lt_u32 s57, 65536
    s_cbranch_scc1 L_RED_pollc
L_RED_gotc:
    v_permlane32_swap_b32 v24, v26
    v_permlane32_swap_b32 v25, v27
    v_add_f32 v24, v24, v26
    v_add_f32 v25, v25, v27
    s_nop 1
    v_permlane16_swap_b32 v24, v25
    v_add_f32 v24, v24, v25
    s_nop 1
    v_add_f32_dpp v24, v24, v24 row_ror:8 row_mask:0xf bank_mask:0xf
    v_fmac_f32 v16, v24, v20
    v_cvt_pk_bf16_f32 v16, v16, v16
    s_mov_b64 exec, s[66:67]
    buffer_store_short v16, v5, s[44:47], s54 offen
    s_mov_b64 exec, -1
L_done:
L_exit:
    s_endpgm

.section .rodata,"a"
.p2align 6
.amdhsa_kernel adaLN_cond__sliding_block_cached__swiglu_ffn__decode_kernel
  .amdhsa_next_free_vgpr 256
  .amdhsa_next_free_sgpr 102
  .amdhsa_accum_offset 256
  .amdhsa_group_segment_fixed_size 0
  .amdhsa_kernarg_size 112
  .amdhsa_user_sgpr_count 2
  .amdhsa_user_sgpr_kernarg_segment_ptr 1
  .amdhsa_system_sgpr_workgroup_id_x 1
  .amdhsa_float_denorm_mode_32 3
  .amdhsa_float_denorm_mode_16_64 3
.end_amdhsa_kernel
```
